```python
import torch

def _softmax(x, axis=-1):
    return torch.softmax(x, dim=axis)
def _gelu(x):
    return torch.nn.functional.gelu(x, approximate="tanh")
def _silu(x):
    return torch.nn.functional.silu(x)
def _sigmoid(x):
    return torch.sigmoid(x)
def _layernorm(x, axis=-1, eps=1e-5):
    m = x.mean(dim=axis, keepdim=True)
    v = x.var(dim=axis, keepdim=True, unbiased=False)
    return (x - m) / torch.sqrt(v + eps)
def _scatter_add(tgt, idx, src, axis=0):
    return tgt.clone().index_add_(axis, idx, src)
def _segment_sum(src, seg, n):
    out = torch.zeros((n,) + src.shape[1:], dtype=src.dtype)
    return out.index_add_(0, seg, src)
def _pad(x, pw):
    flat = tuple(v for pair in reversed(pw) for v in pair)
    return torch.nn.functional.pad(x, flat)

kernel_name = 'concat_heads__linear_attn_block__ssm_conv_s4d__prompt'

def setup_inputs():

    _w = (lambda a: (lambda t: t.to(torch.bfloat16) if t.is_floating_point() else t)(torch.as_tensor(a)))
    def _A_setup():
        B, S, D = 1, 2048, 1024
        return {
            "x": _w((lambda *s: torch.randn(*s, dtype=torch.bfloat16) * 0.05)(B, S, D)),
            "wqkv": _w((lambda *s: torch.randn(*s, dtype=torch.bfloat16) * 0.8)(D, 3 * D)),
            "wo": _w((lambda *s: torch.randn(*s, dtype=torch.bfloat16) * 0.05)(D, D)),
        }
    _A_in = _A_setup()

    def _B_setup():
        Bsz, L, D, N = 1, 2048, 1024, 128
        return {
            "u": _w((lambda *s: torch.randn(*s, dtype=torch.bfloat16) * 0.05)(Bsz, L, D)),
            "log_A_real": _w((lambda *s: torch.randn(*s, dtype=torch.bfloat16) * 3.2)(D, N) * 0.5),
            "A_imag": _w((lambda *s: torch.randn(*s, dtype=torch.bfloat16) * 0.05)(D, N) * 3.14),
            "C_real": _w((lambda *s: torch.randn(*s, dtype=torch.bfloat16) * 0.8)(D, N) / N ** 0.5),
            "C_imag": _w((lambda *s: torch.randn(*s, dtype=torch.bfloat16) * 0.8)(D, N) / N ** 0.5),
            "log_dt": _w((lambda *s: torch.randn(*s, dtype=torch.bfloat16) * 0.05)(D) * 0.5 - 4.0),
            "D_skip": _w((lambda *s: torch.randn(*s, dtype=torch.bfloat16) * 0.1)(D)),
        }
    _B_in = _B_setup()

    return {
        "A_x": _A_in["x"],
        "A_wqkv": _A_in["wqkv"],
        "A_wo": _A_in["wo"],
        "B_u": _B_in["u"],
        "B_log_A_real": _B_in["log_A_real"],
        "B_A_imag": _B_in["A_imag"],
        "B_C_real": _B_in["C_real"],
        "B_C_imag": _B_in["C_imag"],
        "B_log_dt": _B_in["log_dt"],
        "B_D_skip": _B_in["D_skip"],
    }

def reference(A_x, A_wqkv, A_wo, B_u, B_log_A_real, B_A_imag, B_C_real, B_C_imag, B_log_dt, B_D_skip):
    def _A_ref(x, wqkv, wo):
        B, S, D = x.shape
        H = 32; Dh = D // H
        qkv = (lambda x, *d: x.permute(*d))((x @ wqkv).reshape(B, S, 3, H, Dh), 2, 0, 3, 1, 4)
        q, k, v = qkv[0], qkv[1], qkv[2]
        phi = lambda t: torch.where(t > 0, t + 1, torch.exp(t)) + 1e-6
        pq, pk = phi(q), phi(k)
        kv = torch.einsum("bhsd,bhse->bhde", pk, v)
        z = torch.einsum("bhsd->bhd", pk)
        num = torch.einsum("bhqd,bhde->bhqe", pq, kv)
        den = torch.einsum("bhqd,bhd->bhq", pq, z)[..., None] + 1e-6
        o = num / den
        return (lambda x, *d: x.permute(*d))(o, 0, 2, 1, 3).reshape(B, S, D) @ wo

    def _B_ref(u, log_A_real, A_imag, C_real, C_imag, log_dt, D_skip):
        L = u.shape[1]
        dt = torch.exp(log_dt)
        A = -torch.exp(log_A_real) + 1j * A_imag
        C = (C_real + 1j * C_imag) * dt[:, None]
        pos = (lambda x, dt: x.to(dt))(torch.arange(L), log_dt.dtype)
        P = torch.exp((A * dt[:, None])[:, :, None] * pos[None, None, :])
        K = 2.0 * torch.einsum("dn,dnl->dl", C, P).real
        L2 = 2 * L
        u_t = (lambda x, *d: x.permute(*d))(u, 0, 2, 1)
        Kf = (lambda x, *a, **k: torch.fft.rfft(x.float(), *a, **k))(K, L2)
        Uf = (lambda x, *a, **k: torch.fft.rfft(x.float(), *a, **k))(u_t, L2)
        y = (lambda x, *a, **k: torch.fft.irfft(x, *a, **k).to(torch.bfloat16))(Uf * Kf[None, :, :], L2)[:, :, :L]
        y = (lambda x, *d: x.permute(*d))(y, 0, 2, 1)
        return y + u * D_skip[None, None, :]

    a = _A_ref(A_x, A_wqkv, A_wo)
    b = _B_ref(B_u, B_log_A_real, B_A_imag, B_C_real, B_C_imag, B_log_dt, B_D_skip)
    return torch.concatenate([a, b], axis=-1)
```

```asm
; @launch kernel=concat_heads__linear_attn_block__ssm_conv_s4d__prompt_kernel grid=(256,1,1) block=(512,1,1) lds=147456
; @launch kernel=stage2_kernel grid=(256,1,1) block=(256,1,1) lds=67584
.amdgcn_target "amdgcn-amd-amdhsa--gfx950"
.text
.globl concat_heads__linear_attn_block__ssm_conv_s4d__prompt_kernel
.p2align 8
.type concat_heads__linear_attn_block__ssm_conv_s4d__prompt_kernel,@function
concat_heads__linear_attn_block__ssm_conv_s4d__prompt_kernel:
    s_cmp_ge_u32 s2, 256
    s_cbranch_scc1 L_exit
    s_load_dwordx4 s[4:7], s[0:1], 0
    s_load_dwordx4 s[40:43], s[0:1], 88
    s_load_dwordx8 s[68:75], s[0:1], 32
    s_load_dwordx2 s[76:77], s[0:1], 64
    v_and_b32 v1, 63, v0
    v_lshrrev_b32 v2, 6, v0
    s_and_b32 s3, s2, 127
    v_readfirstlane_b32 s24, v2
    s_waitcnt lgkmcnt(0)
    s_mov_b32 s8, s4
    s_and_b32 s9, s5, 0xffff
    s_mov_b32 s10, 4194304
    s_mov_b32 s11, 0x00020000
    s_mov_b32 s12, s6
    s_and_b32 s13, s7, 0xffff
    s_mov_b32 s14, 6291456
    s_mov_b32 s15, 0x00020000
    s_mov_b32 s16, s42
    s_and_b32 s17, s43, 0xffff
    s_mov_b32 s18, 268435456
    s_mov_b32 s19, 0x00020000
    s_mov_b32 s20, s40
    s_and_b32 s21, s41, 0xffff
    s_mov_b32 s22, 256
    s_mov_b32 s23, 0x00020000
    s_bitcmp1_b32 s2, 7
    s_cbranch_scc1 L_phase_bc
    s_and_b32 s25, s3, 1
    s_lshl_b32 s25, s25, 2
    s_lshr_b32 s32, s3, 3
    s_and_b32 s33, s32, 3
    s_add_u32 s25, s25, s33
    s_lshr_b32 s26, s3, 1
    s_and_b32 s26, s26, 3
    s_lshl_b32 s26, s26, 2
    s_lshr_b32 s33, s32, 2
    s_add_u32 s26, s26, s33
    s_lshr_b32 s40, s24, 1
    s_and_b32 s41, s24, 1
    s_lshl_b32 s30, s24, 12
    s_mul_i32 s31, s24, 3072
    s_add_u32 s31, s31, 32768
    s_lshr_b32 s39, s3, 3
    s_lshl_b32 s32, s25, 19
    s_lshl_b32 s33, s24, 16
    s_add_u32 s32, s32, s33
    v_lshrrev_b32 v12, 3, v1
    v_lshrrev_b32 v13, 4, v1
    v_and_b32 v14, 7, v1
    v_xor_b32 v14, v14, v13
    v_xor_b32 v15, 4, v14
    v_lshlrev_b32 v13, 11, v12
    v_lshl_add_u32 v14, v14, 4, v13
    v_lshl_add_u32 v15, v15, 4, v13
    v_add_u32 v200, s32, v14
    v_add_u32 v201, s32, v15
    v_add_u32 v201, 15360, v201
    v_add_u32 v202, 30720, v200
    v_add_u32 v203, 30720, v201
    v_mul_u32_u24 v13, 6144, v12
    v_bfe_u32 v14, v1, 4, 1
    v_lshlrev_b32 v14, 2, v14
    v_and_b32 v15, 7, v1
    v_xor_b32 v14, v14, v15
    v_lshl_add_u32 v13, v14, 4, v13
    s_mul_i32 s34, s24, 3
    s_add_u32 s35, s34, 0
    s_lshr_b32 s36, s35, 3
    s_and_b32 s37, s35, 7
    s_mul_i32 s37, s37, 49152
    s_lshl_b32 s36, s36, 11
    s_add_u32 s37, s37, s36
    s_lshl_b32 s36, s26, 7
    s_add_u32 s37, s37, s36
    v_add_u32 v204, s37, v13
    s_add_u32 s35, s34, 1
    s_lshr_b32 s36, s35, 3
    s_and_b32 s37, s35, 7
    s_mul_i32 s37, s37, 49152
    s_lshl_b32 s36, s36, 11
    s_add_u32 s37, s37, s36
    s_lshl_b32 s36, s26, 7
    s_add_u32 s37, s37, s36
    s_sub_u32 s37, s37, 1024
    v_add_u32 v205, s37, v13
    s_add_u32 s35, s34, 2
    s_lshr_b32 s36, s35, 3
    s_and_b32 s37, s35, 7
    s_mul_i32 s37, s37, 49152
    s_lshl_b32 s36, s36, 11
    s_add_u32 s37, s37, s36
    s_lshl_b32 s36, s26, 7
    s_add_u32 s37, s37, s36
    s_sub_u32 s37, s37, 2048
    v_add_u32 v206, s37, v13
    s_add_u32 s37, s39, 0
    s_and_b32 s37, s37, 15
    s_lshl_b32 s36, s37, 7
    s_mul_i32 s37, s37, 393216
    s_add_u32 m0, s31, 0
    s_nop 0
    buffer_load_dwordx4 v204, s[12:15], s37 offen offset:0 lds
    buffer_load_dwordx4 v205, s[12:15], s37 offen offset:1024 lds
    buffer_load_dwordx4 v206, s[12:15], s37 offen offset:2048 lds
    s_add_u32 m0, s30, 0
    s_nop 0
    buffer_load_dwordx4 v200, s[8:11], s36 offen offset:0 lds
    buffer_load_dwordx4 v201, s[8:11], s36 offen offset:1024 lds
    buffer_load_dwordx4 v202, s[8:11], s36 offen offset:2048 lds
    buffer_load_dwordx4 v203, s[8:11], s36 offen offset:3072 lds
    s_add_u32 s37, s39, 1
    s_and_b32 s37, s37, 15
    s_lshl_b32 s36, s37, 7
    s_mul_i32 s37, s37, 393216
    s_add_u32 m0, s31, 57344
    s_nop 0
    buffer_load_dwordx4 v204, s[12:15], s37 offen offset:0 lds
    buffer_load_dwordx4 v205, s[12:15], s37 offen offset:1024 lds
    buffer_load_dwordx4 v206, s[12:15], s37 offen offset:2048 lds
    s_add_u32 m0, s30, 57344
    s_nop 0
    buffer_load_dwordx4 v200, s[8:11], s36 offen offset:0 lds
    buffer_load_dwordx4 v201, s[8:11], s36 offen offset:1024 lds
    buffer_load_dwordx4 v202, s[8:11], s36 offen offset:2048 lds
    buffer_load_dwordx4 v203, s[8:11], s36 offen offset:3072 lds
    v_and_b32 v12, 31, v1
    v_lshrrev_b32 v13, 5, v1
    v_bfe_u32 v14, v12, 1, 3
    v_xor_b32 v13, v13, v14
    v_lshlrev_b32 v12, 7, v12
    v_lshl_add_u32 v12, v13, 4, v12
    s_lshl_b32 s32, s40, 13
    v_add_u32 v6, s32, v12
    v_xor_b32 v7, 32, v6
    v_xor_b32 v8, 64, v6
    v_xor_b32 v9, 96, v6
    v_lshrrev_b32 v12, 5, v1
    v_lshlrev_b32 v12, 3, v12
    v_bfe_u32 v13, v1, 2, 2
    v_add_u32 v12, v12, v13
    v_lshlrev_b32 v12, 7, v12
    v_bfe_u32 v13, v1, 3, 1
    v_xor_b32 v13, s41, v13
    v_lshl_add_u32 v12, v13, 6, v12
    v_bfe_u32 v13, v1, 4, 1
    v_lshl_add_u32 v12, v13, 5, v12
    v_and_b32 v13, 3, v1
    v_lshl_add_u32 v12, v13, 3, v12
    v_add_u32 v11, 32768, v12
    v_add_u32 v164, 57344, v6
    v_add_u32 v165, 57344, v7
    v_add_u32 v166, 57344, v8
    v_add_u32 v167, 57344, v9
    v_add_u32 v176, 57344, v11
    s_mov_b32 s60, 1069066811
    s_mov_b32 s61, 1069066811
    s_mov_b32 s62, 0x358637bd
    s_mov_b32 s63, 0x358637bd
    s_waitcnt vmcnt(7)
    s_barrier
    ds_read_b64_tr_b16 v[32:33], v11 offset:0
    ds_read_b64_tr_b16 v[34:35], v11 offset:512
    ds_read_b128 v[16:19], v6 offset:0
    ds_read_b128 v[20:23], v6 offset:4096
    ds_read_b64_tr_b16 v[36:37], v11 offset:8192
    ds_read_b64_tr_b16 v[38:39], v11 offset:8704
    ds_read_b64_tr_b16 v[40:41], v11 offset:16384
    ds_read_b64_tr_b16 v[42:43], v11 offset:16896
    s_waitcnt lgkmcnt(0)
    v_mfma_f32_32x32x16_bf16 v[64:79], v[32:35], v[16:19], 0
    ds_read_b64_tr_b16 v[44:45], v11 offset:2048
    ds_read_b64_tr_b16 v[46:47], v11 offset:2560
    ds_read_b128 v[24:27], v7 offset:0
    v_mfma_f32_32x32x16_bf16 v[80:95], v[32:35], v[20:23], 0
    ds_read_b128 v[28:31], v7 offset:4096
    ds_read_b64_tr_b16 v[48:49], v11 offset:10240
    ds_read_b64_tr_b16 v[50:51], v11 offset:10752
    v_mfma_f32_32x32x16_bf16 v[96:111], v[16:19], v[36:39], 0
    ds_read_b64_tr_b16 v[52:53], v11 offset:18432
    ds_read_b64_tr_b16 v[54:55], v11 offset:18944
    v_mfma_f32_32x32x16_bf16 v[112:127], v[20:23], v[36:39], 0
    v_mfma_f32_32x32x16_bf16 v[128:143], v[16:19], v[40:43], 0
    v_mfma_f32_32x32x16_bf16 v[144:159], v[20:23], v[40:43], 0
    s_waitcnt lgkmcnt(0)
    v_mfma_f32_32x32x16_bf16 v[64:79], v[44:47], v[24:27], v[64:79]
    ds_read_b64_tr_b16 v[32:33], v11 offset:4096
    ds_read_b64_tr_b16 v[34:35], v11 offset:4608
    ds_read_b128 v[16:19], v8 offset:0
    v_mfma_f32_32x32x16_bf16 v[80:95], v[44:47], v[28:31], v[80:95]
    ds_read_b128 v[20:23], v8 offset:4096
    ds_read_b64_tr_b16 v[36:37], v11 offset:12288
    ds_read_b64_tr_b16 v[38:39], v11 offset:12800
    v_mfma_f32_32x32x16_bf16 v[96:111], v[24:27], v[48:51], v[96:111]
    ds_read_b64_tr_b16 v[40:41], v11 offset:20480
    ds_read_b64_tr_b16 v[42:43], v11 offset:20992
    v_mfma_f32_32x32x16_bf16 v[112:127], v[28:31], v[48:51], v[112:127]
    v_mfma_f32_32x32x16_bf16 v[128:143], v[24:27], v[52:55], v[128:143]
    v_mfma_f32_32x32x16_bf16 v[144:159], v[28:31], v[52:55], v[144:159]
    s_waitcnt lgkmcnt(0)
    v_mfma_f32_32x32x16_bf16 v[64:79], v[32:35], v[16:19], v[64:79]
    ds_read_b64_tr_b16 v[44:45], v11 offset:6144
    ds_read_b64_tr_b16 v[46:47], v11 offset:6656
    ds_read_b128 v[24:27], v9 offset:0
    v_mfma_f32_32x32x16_bf16 v[80:95], v[32:35], v[20:23], v[80:95]
    ds_read_b128 v[28:31], v9 offset:4096
    ds_read_b64_tr_b16 v[48:49], v11 offset:14336
    ds_read_b64_tr_b16 v[50:51], v11 offset:14848
    v_mfma_f32_32x32x16_bf16 v[96:111], v[16:19], v[36:39], v[96:111]
    ds_read_b64_tr_b16 v[52:53], v11 offset:22528
    ds_read_b64_tr_b16 v[54:55], v11 offset:23040
    v_mfma_f32_32x32x16_bf16 v[112:127], v[20:23], v[36:39], v[112:127]
    v_mfma_f32_32x32x16_bf16 v[128:143], v[16:19], v[40:43], v[128:143]
    v_mfma_f32_32x32x16_bf16 v[144:159], v[20:23], v[40:43], v[144:159]
    s_waitcnt lgkmcnt(0)
    v_mfma_f32_32x32x16_bf16 v[64:79], v[44:47], v[24:27], v[64:79]
    s_waitcnt vmcnt(0)
    s_barrier
    ds_read_b64_tr_b16 v[32:33], v176 offset:0
    ds_read_b64_tr_b16 v[34:35], v176 offset:512
    ds_read_b128 v[16:19], v164 offset:0
    v_mfma_f32_32x32x16_bf16 v[80:95], v[44:47], v[28:31], v[80:95]
    ds_read_b128 v[20:23], v164 offset:4096
    ds_read_b64_tr_b16 v[36:37], v176 offset:8192
    ds_read_b64_tr_b16 v[38:39], v176 offset:8704
    v_mfma_f32_32x32x16_bf16 v[96:111], v[24:27], v[48:51], v[96:111]
    ds_read_b64_tr_b16 v[40:41], v176 offset:16384
    ds_read_b64_tr_b16 v[42:43], v176 offset:16896
    v_mfma_f32_32x32x16_bf16 v[112:127], v[28:31], v[48:51], v[112:127]
    s_add_u32 s37, s39, 2
    s_and_b32 s37, s37, 15
    s_lshl_b32 s36, s37, 7
    s_mul_i32 s37, s37, 393216
    s_add_u32 m0, s31, 0
    s_nop 0
    buffer_load_dwordx4 v204, s[12:15], s37 offen offset:0 lds
    v_mfma_f32_32x32x16_bf16 v[128:143], v[24:27], v[52:55], v[128:143]
    buffer_load_dwordx4 v205, s[12:15], s37 offen offset:1024 lds
    v_mfma_f32_32x32x16_bf16 v[144:159], v[28:31], v[52:55], v[144:159]
    buffer_load_dwordx4 v206, s[12:15], s37 offen offset:2048 lds
    s_add_u32 m0, s30, 0
    s_nop 0
    buffer_load_dwordx4 v200, s[8:11], s36 offen offset:0 lds
    s_waitcnt lgkmcnt(0)
    v_mfma_f32_32x32x16_bf16 v[64:79], v[32:35], v[16:19], v[64:79]
    ds_read_b64_tr_b16 v[44:45], v176 offset:2048
    ds_read_b64_tr_b16 v[46:47], v176 offset:2560
    ds_read_b128 v[24:27], v165 offset:0
    v_mfma_f32_32x32x16_bf16 v[80:95], v[32:35], v[20:23], v[80:95]
    ds_read_b128 v[28:31], v165 offset:4096
    ds_read_b64_tr_b16 v[48:49], v176 offset:10240
    ds_read_b64_tr_b16 v[50:51], v176 offset:10752
    v_mfma_f32_32x32x16_bf16 v[96:111], v[16:19], v[36:39], v[96:111]
    ds_read_b64_tr_b16 v[52:53], v176 offset:18432
    ds_read_b64_tr_b16 v[54:55], v176 offset:18944
    v_mfma_f32_32x32x16_bf16 v[112:127], v[20:23], v[36:39], v[112:127]
    buffer_load_dwordx4 v201, s[8:11], s36 offen offset:1024 lds
    v_mfma_f32_32x32x16_bf16 v[128:143], v[16:19], v[40:43], v[128:143]
    buffer_load_dwordx4 v202, s[8:11], s36 offen offset:2048 lds
    v_mfma_f32_32x32x16_bf16 v[144:159], v[20:23], v[40:43], v[144:159]
    buffer_load_dwordx4 v203, s[8:11], s36 offen offset:3072 lds
    s_waitcnt lgkmcnt(0)
    v_mfma_f32_32x32x16_bf16 v[64:79], v[44:47], v[24:27], v[64:79]
    ds_read_b64_tr_b16 v[32:33], v176 offset:4096
    ds_read_b64_tr_b16 v[34:35], v176 offset:4608
    ds_read_b128 v[16:19], v166 offset:0
    v_mfma_f32_32x32x16_bf16 v[80:95], v[44:47], v[28:31], v[80:95]
    ds_read_b128 v[20:23], v166 offset:4096
    ds_read_b64_tr_b16 v[36:37], v176 offset:12288
    ds_read_b64_tr_b16 v[38:39], v176 offset:12800
    v_mfma_f32_32x32x16_bf16 v[96:111], v[24:27], v[48:51], v[96:111]
    ds_read_b64_tr_b16 v[40:41], v176 offset:20480
    ds_read_b64_tr_b16 v[42:43], v176 offset:20992
    v_mfma_f32_32x32x16_bf16 v[112:127], v[28:31], v[48:51], v[112:127]
    v_mfma_f32_32x32x16_bf16 v[128:143], v[24:27], v[52:55], v[128:143]
    v_mfma_f32_32x32x16_bf16 v[144:159], v[28:31], v[52:55], v[144:159]
    s_waitcnt lgkmcnt(0)
    v_mfma_f32_32x32x16_bf16 v[64:79], v[32:35], v[16:19], v[64:79]
    ds_read_b64_tr_b16 v[44:45], v176 offset:6144
    ds_read_b64_tr_b16 v[46:47], v176 offset:6656
    ds_read_b128 v[24:27], v167 offset:0
    v_mfma_f32_32x32x16_bf16 v[80:95], v[32:35], v[20:23], v[80:95]
    ds_read_b128 v[28:31], v167 offset:4096
    ds_read_b64_tr_b16 v[48:49], v176 offset:14336
    ds_read_b64_tr_b16 v[50:51], v176 offset:14848
    v_mfma_f32_32x32x16_bf16 v[96:111], v[16:19], v[36:39], v[96:111]
    ds_read_b64_tr_b16 v[52:53], v176 offset:22528
    ds_read_b64_tr_b16 v[54:55], v176 offset:23040
    v_mfma_f32_32x32x16_bf16 v[112:127], v[20:23], v[36:39], v[112:127]
    v_mfma_f32_32x32x16_bf16 v[128:143], v[16:19], v[40:43], v[128:143]
    v_mfma_f32_32x32x16_bf16 v[144:159], v[20:23], v[40:43], v[144:159]
    s_waitcnt lgkmcnt(0)
    v_mfma_f32_32x32x16_bf16 v[64:79], v[44:47], v[24:27], v[64:79]
    s_waitcnt vmcnt(0)
    s_barrier
    ds_read_b64_tr_b16 v[32:33], v11 offset:0
    ds_read_b64_tr_b16 v[34:35], v11 offset:512
    ds_read_b128 v[16:19], v6 offset:0
    v_mfma_f32_32x32x16_bf16 v[80:95], v[44:47], v[28:31], v[80:95]
    ds_read_b128 v[20:23], v6 offset:4096
    ds_read_b64_tr_b16 v[36:37], v11 offset:8192
    ds_read_b64_tr_b16 v[38:39], v11 offset:8704
    v_mfma_f32_32x32x16_bf16 v[96:111], v[24:27], v[48:51], v[96:111]
    ds_read_b64_tr_b16 v[40:41], v11 offset:16384
    ds_read_b64_tr_b16 v[42:43], v11 offset:16896
    v_mfma_f32_32x32x16_bf16 v[112:127], v[28:31], v[48:51], v[112:127]
    s_add_u32 s37, s39, 3
    s_and_b32 s37, s37, 15
    s_lshl_b32 s36, s37, 7
    s_mul_i32 s37, s37, 393216
    s_add_u32 m0, s31, 57344
    s_nop 0
    buffer_load_dwordx4 v204, s[12:15], s37 offen offset:0 lds
    v_mfma_f32_32x32x16_bf16 v[128:143], v[24:27], v[52:55], v[128:143]
    buffer_load_dwordx4 v205, s[12:15], s37 offen offset:1024 lds
    v_mfma_f32_32x32x16_bf16 v[144:159], v[28:31], v[52:55], v[144:159]
    buffer_load_dwordx4 v206, s[12:15], s37 offen offset:2048 lds
    s_add_u32 m0, s30, 57344
    s_nop 0
    buffer_load_dwordx4 v200, s[8:11], s36 offen offset:0 lds
    s_waitcnt lgkmcnt(0)
    v_mfma_f32_32x32x16_bf16 v[64:79], v[32:35], v[16:19], v[64:79]
    ds_read_b64_tr_b16 v[44:45], v11 offset:2048
    ds_read_b64_tr_b16 v[46:47], v11 offset:2560
    ds_read_b128 v[24:27], v7 offset:0
    v_mfma_f32_32x32x16_bf16 v[80:95], v[32:35], v[20:23], v[80:95]
    ds_read_b128 v[28:31], v7 offset:4096
    ds_read_b64_tr_b16 v[48:49], v11 offset:10240
    ds_read_b64_tr_b16 v[50:51], v11 offset:10752
    v_mfma_f32_32x32x16_bf16 v[96:111], v[16:19], v[36:39], v[96:111]
    ds_read_b64_tr_b16 v[52:53], v11 offset:18432
    ds_read_b64_tr_b16 v[54:55], v11 offset:18944
    v_mfma_f32_32x32x16_bf16 v[112:127], v[20:23], v[36:39], v[112:127]
    buffer_load_dwordx4 v201, s[8:11], s36 offen offset:1024 lds
    v_mfma_f32_32x32x16_bf16 v[128:143], v[16:19], v[40:43], v[128:143]
    buffer_load_dwordx4 v202, s[8:11], s36 offen offset:2048 lds
    v_mfma_f32_32x32x16_bf16 v[144:159], v[20:23], v[40:43], v[144:159]
    buffer_load_dwordx4 v203, s[8:11], s36 offen offset:3072 lds
    s_waitcnt lgkmcnt(0)
    v_mfma_f32_32x32x16_bf16 v[64:79], v[44:47], v[24:27], v[64:79]
    ds_read_b64_tr_b16 v[32:33], v11 offset:4096
    ds_read_b64_tr_b16 v[34:35], v11 offset:4608
    ds_read_b128 v[16:19], v8 offset:0
    v_mfma_f32_32x32x16_bf16 v[80:95], v[44:47], v[28:31], v[80:95]
    ds_read_b128 v[20:23], v8 offset:4096
    ds_read_b64_tr_b16 v[36:37], v11 offset:12288
    ds_read_b64_tr_b16 v[38:39], v11 offset:12800
    v_mfma_f32_32x32x16_bf16 v[96:111], v[24:27], v[48:51], v[96:111]
    ds_read_b64_tr_b16 v[40:41], v11 offset:20480
    ds_read_b64_tr_b16 v[42:43], v11 offset:20992
    v_mfma_f32_32x32x16_bf16 v[112:127], v[28:31], v[48:51], v[112:127]
    v_mfma_f32_32x32x16_bf16 v[128:143], v[24:27], v[52:55], v[128:143]
    v_mfma_f32_32x32x16_bf16 v[144:159], v[28:31], v[52:55], v[144:159]
    s_waitcnt lgkmcnt(0)
    v_mfma_f32_32x32x16_bf16 v[64:79], v[32:35], v[16:19], v[64:79]
    ds_read_b64_tr_b16 v[44:45], v11 offset:6144
    ds_read_b64_tr_b16 v[46:47], v11 offset:6656
    ds_read_b128 v[24:27], v9 offset:0
    v_mfma_f32_32x32x16_bf16 v[80:95], v[32:35], v[20:23], v[80:95]
    ds_read_b128 v[28:31], v9 offset:4096
    ds_read_b64_tr_b16 v[48:49], v11 offset:14336
    ds_read_b64_tr_b16 v[50:51], v11 offset:14848
    v_mfma_f32_32x32x16_bf16 v[96:111], v[16:19], v[36:39], v[96:111]
    ds_read_b64_tr_b16 v[52:53], v11 offset:22528
    ds_read_b64_tr_b16 v[54:55], v11 offset:23040
    v_mfma_f32_32x32x16_bf16 v[112:127], v[20:23], v[36:39], v[112:127]
    v_mfma_f32_32x32x16_bf16 v[128:143], v[16:19], v[40:43], v[128:143]
    v_mfma_f32_32x32x16_bf16 v[144:159], v[20:23], v[40:43], v[144:159]
    s_waitcnt lgkmcnt(0)
    v_mfma_f32_32x32x16_bf16 v[64:79], v[44:47], v[24:27], v[64:79]
    s_waitcnt vmcnt(0)
    s_barrier
    ds_read_b64_tr_b16 v[32:33], v176 offset:0
    ds_read_b64_tr_b16 v[34:35], v176 offset:512
    ds_read_b128 v[16:19], v164 offset:0
    v_mfma_f32_32x32x16_bf16 v[80:95], v[44:47], v[28:31], v[80:95]
    ds_read_b128 v[20:23], v164 offset:4096
    ds_read_b64_tr_b16 v[36:37], v176 offset:8192
    ds_read_b64_tr_b16 v[38:39], v176 offset:8704
    v_mfma_f32_32x32x16_bf16 v[96:111], v[24:27], v[48:51], v[96:111]
    ds_read_b64_tr_b16 v[40:41], v176 offset:16384
    ds_read_b64_tr_b16 v[42:43], v176 offset:16896
    v_mfma_f32_32x32x16_bf16 v[112:127], v[28:31], v[48:51], v[112:127]
    s_add_u32 s37, s39, 4
    s_and_b32 s37, s37, 15
    s_lshl_b32 s36, s37, 7
    s_mul_i32 s37, s37, 393216
    s_add_u32 m0, s31, 0
    s_nop 0
    buffer_load_dwordx4 v204, s[12:15], s37 offen offset:0 lds
    v_mfma_f32_32x32x16_bf16 v[128:143], v[24:27], v[52:55], v[128:143]
    buffer_load_dwordx4 v205, s[12:15], s37 offen offset:1024 lds
    v_mfma_f32_32x32x16_bf16 v[144:159], v[28:31], v[52:55], v[144:159]
    buffer_load_dwordx4 v206, s[12:15], s37 offen offset:2048 lds
    s_add_u32 m0, s30, 0
    s_nop 0
    buffer_load_dwordx4 v200, s[8:11], s36 offen offset:0 lds
    s_waitcnt lgkmcnt(0)
    v_mfma_f32_32x32x16_bf16 v[64:79], v[32:35], v[16:19], v[64:79]
    ds_read_b64_tr_b16 v[44:45], v176 offset:2048
    ds_read_b64_tr_b16 v[46:47], v176 offset:2560
    ds_read_b128 v[24:27], v165 offset:0
    v_mfma_f32_32x32x16_bf16 v[80:95], v[32:35], v[20:23], v[80:95]
    ds_read_b128 v[28:31], v165 offset:4096
    ds_read_b64_tr_b16 v[48:49], v176 offset:10240
    ds_read_b64_tr_b16 v[50:51], v176 offset:10752
    v_mfma_f32_32x32x16_bf16 v[96:111], v[16:19], v[36:39], v[96:111]
    ds_read_b64_tr_b16 v[52:53], v176 offset:18432
    ds_read_b64_tr_b16 v[54:55], v176 offset:18944
    v_mfma_f32_32x32x16_bf16 v[112:127], v[20:23], v[36:39], v[112:127]
    buffer_load_dwordx4 v201, s[8:11], s36 offen offset:1024 lds
    v_mfma_f32_32x32x16_bf16 v[128:143], v[16:19], v[40:43], v[128:143]
    buffer_load_dwordx4 v202, s[8:11], s36 offen offset:2048 lds
    v_mfma_f32_32x32x16_bf16 v[144:159], v[20:23], v[40:43], v[144:159]
    buffer_load_dwordx4 v203, s[8:11], s36 offen offset:3072 lds
    s_waitcnt lgkmcnt(0)
    v_mfma_f32_32x32x16_bf16 v[64:79], v[44:47], v[24:27], v[64:79]
    ds_read_b64_tr_b16 v[32:33], v176 offset:4096
    ds_read_b64_tr_b16 v[34:35], v176 offset:4608
    ds_read_b128 v[16:19], v166 offset:0
    v_mfma_f32_32x32x16_bf16 v[80:95], v[44:47], v[28:31], v[80:95]
    ds_read_b128 v[20:23], v166 offset:4096
    ds_read_b64_tr_b16 v[36:37], v176 offset:12288
    ds_read_b64_tr_b16 v[38:39], v176 offset:12800
    v_mfma_f32_32x32x16_bf16 v[96:111], v[24:27], v[48:51], v[96:111]
    ds_read_b64_tr_b16 v[40:41], v176 offset:20480
    ds_read_b64_tr_b16 v[42:43], v176 offset:20992
    v_mfma_f32_32x32x16_bf16 v[112:127], v[28:31], v[48:51], v[112:127]
    v_mfma_f32_32x32x16_bf16 v[128:143], v[24:27], v[52:55], v[128:143]
    v_mfma_f32_32x32x16_bf16 v[144:159], v[28:31], v[52:55], v[144:159]
    s_waitcnt lgkmcnt(0)
    v_mfma_f32_32x32x16_bf16 v[64:79], v[32:35], v[16:19], v[64:79]
    ds_read_b64_tr_b16 v[44:45], v176 offset:6144
    ds_read_b64_tr_b16 v[46:47], v176 offset:6656
    ds_read_b128 v[24:27], v167 offset:0
    v_mfma_f32_32x32x16_bf16 v[80:95], v[32:35], v[20:23], v[80:95]
    ds_read_b128 v[28:31], v167 offset:4096
    ds_read_b64_tr_b16 v[48:49], v176 offset:14336
    ds_read_b64_tr_b16 v[50:51], v176 offset:14848
    v_mfma_f32_32x32x16_bf16 v[96:111], v[16:19], v[36:39], v[96:111]
    ds_read_b64_tr_b16 v[52:53], v176 offset:22528
    ds_read_b64_tr_b16 v[54:55], v176 offset:23040
    v_mfma_f32_32x32x16_bf16 v[112:127], v[20:23], v[36:39], v[112:127]
    v_mfma_f32_32x32x16_bf16 v[128:143], v[16:19], v[40:43], v[128:143]
    v_mfma_f32_32x32x16_bf16 v[144:159], v[20:23], v[40:43], v[144:159]
    s_waitcnt lgkmcnt(0)
    v_mfma_f32_32x32x16_bf16 v[64:79], v[44:47], v[24:27], v[64:79]
    s_waitcnt vmcnt(0)
    s_barrier
    ds_read_b64_tr_b16 v[32:33], v11 offset:0
    ds_read_b64_tr_b16 v[34:35], v11 offset:512
    ds_read_b128 v[16:19], v6 offset:0
    v_mfma_f32_32x32x16_bf16 v[80:95], v[44:47], v[28:31], v[80:95]
    ds_read_b128 v[20:23], v6 offset:4096
    ds_read_b64_tr_b16 v[36:37], v11 offset:8192
    ds_read_b64_tr_b16 v[38:39], v11 offset:8704
    v_mfma_f32_32x32x16_bf16 v[96:111], v[24:27], v[48:51], v[96:111]
    ds_read_b64_tr_b16 v[40:41], v11 offset:16384
    ds_read_b64_tr_b16 v[42:43], v11 offset:16896
    v_mfma_f32_32x32x16_bf16 v[112:127], v[28:31], v[48:51], v[112:127]
    s_add_u32 s37, s39, 5
    s_and_b32 s37, s37, 15
    s_lshl_b32 s36, s37, 7
    s_mul_i32 s37, s37, 393216
    s_add_u32 m0, s31, 57344
    s_nop 0
    buffer_load_dwordx4 v204, s[12:15], s37 offen offset:0 lds
    v_mfma_f32_32x32x16_bf16 v[128:143], v[24:27], v[52:55], v[128:143]
    buffer_load_dwordx4 v205, s[12:15], s37 offen offset:1024 lds
    v_mfma_f32_32x32x16_bf16 v[144:159], v[28:31], v[52:55], v[144:159]
    buffer_load_dwordx4 v206, s[12:15], s37 offen offset:2048 lds
    s_add_u32 m0, s30, 57344
    s_nop 0
    buffer_load_dwordx4 v200, s[8:11], s36 offen offset:0 lds
    s_waitcnt lgkmcnt(0)
    v_mfma_f32_32x32x16_bf16 v[64:79], v[32:35], v[16:19], v[64:79]
    ds_read_b64_tr_b16 v[44:45], v11 offset:2048
    ds_read_b64_tr_b16 v[46:47], v11 offset:2560
    ds_read_b128 v[24:27], v7 offset:0
    v_mfma_f32_32x32x16_bf16 v[80:95], v[32:35], v[20:23], v[80:95]
    ds_read_b128 v[28:31], v7 offset:4096
    ds_read_b64_tr_b16 v[48:49], v11 offset:10240
    ds_read_b64_tr_b16 v[50:51], v11 offset:10752
    v_mfma_f32_32x32x16_bf16 v[96:111], v[16:19], v[36:39], v[96:111]
    ds_read_b64_tr_b16 v[52:53], v11 offset:18432
    ds_read_b64_tr_b16 v[54:55], v11 offset:18944
    v_mfma_f32_32x32x16_bf16 v[112:127], v[20:23], v[36:39], v[112:127]
    buffer_load_dwordx4 v201, s[8:11], s36 offen offset:1024 lds
    v_mfma_f32_32x32x16_bf16 v[128:143], v[16:19], v[40:43], v[128:143]
    buffer_load_dwordx4 v202, s[8:11], s36 offen offset:2048 lds
    v_mfma_f32_32x32x16_bf16 v[144:159], v[20:23], v[40:43], v[144:159]
    buffer_load_dwordx4 v203, s[8:11], s36 offen offset:3072 lds
    s_waitcnt lgkmcnt(0)
    v_mfma_f32_32x32x16_bf16 v[64:79], v[44:47], v[24:27], v[64:79]
    ds_read_b64_tr_b16 v[32:33], v11 offset:4096
    ds_read_b64_tr_b16 v[34:35], v11 offset:4608
    ds_read_b128 v[16:19], v8 offset:0
    v_mfma_f32_32x32x16_bf16 v[80:95], v[44:47], v[28:31], v[80:95]
    ds_read_b128 v[20:23], v8 offset:4096
    ds_read_b64_tr_b16 v[36:37], v11 offset:12288
    ds_read_b64_tr_b16 v[38:39], v11 offset:12800
    v_mfma_f32_32x32x16_bf16 v[96:111], v[24:27], v[48:51], v[96:111]
    ds_read_b64_tr_b16 v[40:41], v11 offset:20480
    ds_read_b64_tr_b16 v[42:43], v11 offset:20992
    v_mfma_f32_32x32x16_bf16 v[112:127], v[28:31], v[48:51], v[112:127]
    v_mfma_f32_32x32x16_bf16 v[128:143], v[24:27], v[52:55], v[128:143]
    v_mfma_f32_32x32x16_bf16 v[144:159], v[28:31], v[52:55], v[144:159]
    s_waitcnt lgkmcnt(0)
    v_mfma_f32_32x32x16_bf16 v[64:79], v[32:35], v[16:19], v[64:79]
    ds_read_b64_tr_b16 v[44:45], v11 offset:6144
    ds_read_b64_tr_b16 v[46:47], v11 offset:6656
    ds_read_b128 v[24:27], v9 offset:0
    v_mfma_f32_32x32x16_bf16 v[80:95], v[32:35], v[20:23], v[80:95]
    ds_read_b128 v[28:31], v9 offset:4096
    ds_read_b64_tr_b16 v[48:49], v11 offset:14336
    ds_read_b64_tr_b16 v[50:51], v11 offset:14848
    v_mfma_f32_32x32x16_bf16 v[96:111], v[16:19], v[36:39], v[96:111]
    ds_read_b64_tr_b16 v[52:53], v11 offset:22528
    ds_read_b64_tr_b16 v[54:55], v11 offset:23040
    v_mfma_f32_32x32x16_bf16 v[112:127], v[20:23], v[36:39], v[112:127]
    v_mfma_f32_32x32x16_bf16 v[128:143], v[16:19], v[40:43], v[128:143]
    v_mfma_f32_32x32x16_bf16 v[144:159], v[20:23], v[40:43], v[144:159]
    s_waitcnt lgkmcnt(0)
    v_mfma_f32_32x32x16_bf16 v[64:79], v[44:47], v[24:27], v[64:79]
    s_waitcnt vmcnt(0)
    s_barrier
    ds_read_b64_tr_b16 v[32:33], v176 offset:0
    ds_read_b64_tr_b16 v[34:35], v176 offset:512
    ds_read_b128 v[16:19], v164 offset:0
    v_mfma_f32_32x32x16_bf16 v[80:95], v[44:47], v[28:31], v[80:95]
    ds_read_b128 v[20:23], v164 offset:4096
    ds_read_b64_tr_b16 v[36:37], v176 offset:8192
    ds_read_b64_tr_b16 v[38:39], v176 offset:8704
    v_mfma_f32_32x32x16_bf16 v[96:111], v[24:27], v[48:51], v[96:111]
    ds_read_b64_tr_b16 v[40:41], v176 offset:16384
    ds_read_b64_tr_b16 v[42:43], v176 offset:16896
    v_mfma_f32_32x32x16_bf16 v[112:127], v[28:31], v[48:51], v[112:127]
    s_add_u32 s37, s39, 6
    s_and_b32 s37, s37, 15
    s_lshl_b32 s36, s37, 7
    s_mul_i32 s37, s37, 393216
    s_add_u32 m0, s31, 0
    s_nop 0
    buffer_load_dwordx4 v204, s[12:15], s37 offen offset:0 lds
    v_mfma_f32_32x32x16_bf16 v[128:143], v[24:27], v[52:55], v[128:143]
    buffer_load_dwordx4 v205, s[12:15], s37 offen offset:1024 lds
    v_mfma_f32_32x32x16_bf16 v[144:159], v[28:31], v[52:55], v[144:159]
    buffer_load_dwordx4 v206, s[12:15], s37 offen offset:2048 lds
    s_add_u32 m0, s30, 0
    s_nop 0
    buffer_load_dwordx4 v200, s[8:11], s36 offen offset:0 lds
    s_waitcnt lgkmcnt(0)
    v_mfma_f32_32x32x16_bf16 v[64:79], v[32:35], v[16:19], v[64:79]
    ds_read_b64_tr_b16 v[44:45], v176 offset:2048
    ds_read_b64_tr_b16 v[46:47], v176 offset:2560
    ds_read_b128 v[24:27], v165 offset:0
    v_mfma_f32_32x32x16_bf16 v[80:95], v[32:35], v[20:23], v[80:95]
    ds_read_b128 v[28:31], v165 offset:4096
    ds_read_b64_tr_b16 v[48:49], v176 offset:10240
    ds_read_b64_tr_b16 v[50:51], v176 offset:10752
    v_mfma_f32_32x32x16_bf16 v[96:111], v[16:19], v[36:39], v[96:111]
    ds_read_b64_tr_b16 v[52:53], v176 offset:18432
    ds_read_b64_tr_b16 v[54:55], v176 offset:18944
    v_mfma_f32_32x32x16_bf16 v[112:127], v[20:23], v[36:39], v[112:127]
    buffer_load_dwordx4 v201, s[8:11], s36 offen offset:1024 lds
    v_mfma_f32_32x32x16_bf16 v[128:143], v[16:19], v[40:43], v[128:143]
    buffer_load_dwordx4 v202, s[8:11], s36 offen offset:2048 lds
    v_mfma_f32_32x32x16_bf16 v[144:159], v[20:23], v[40:43], v[144:159]
    buffer_load_dwordx4 v203, s[8:11], s36 offen offset:3072 lds
    s_waitcnt lgkmcnt(0)
    v_mfma_f32_32x32x16_bf16 v[64:79], v[44:47], v[24:27], v[64:79]
    ds_read_b64_tr_b16 v[32:33], v176 offset:4096
    ds_read_b64_tr_b16 v[34:35], v176 offset:4608
    ds_read_b128 v[16:19], v166 offset:0
    v_mfma_f32_32x32x16_bf16 v[80:95], v[44:47], v[28:31], v[80:95]
    ds_read_b128 v[20:23], v166 offset:4096
    ds_read_b64_tr_b16 v[36:37], v176 offset:12288
    ds_read_b64_tr_b16 v[38:39], v176 offset:12800
    v_mfma_f32_32x32x16_bf16 v[96:111], v[24:27], v[48:51], v[96:111]
    ds_read_b64_tr_b16 v[40:41], v176 offset:20480
    ds_read_b64_tr_b16 v[42:43], v176 offset:20992
    v_mfma_f32_32x32x16_bf16 v[112:127], v[28:31], v[48:51], v[112:127]
    v_mfma_f32_32x32x16_bf16 v[128:143], v[24:27], v[52:55], v[128:143]
    v_mfma_f32_32x32x16_bf16 v[144:159], v[28:31], v[52:55], v[144:159]
    s_waitcnt lgkmcnt(0)
    v_mfma_f32_32x32x16_bf16 v[64:79], v[32:35], v[16:19], v[64:79]
    ds_read_b64_tr_b16 v[44:45], v176 offset:6144
    ds_read_b64_tr_b16 v[46:47], v176 offset:6656
    ds_read_b128 v[24:27], v167 offset:0
    v_mfma_f32_32x32x16_bf16 v[80:95], v[32:35], v[20:23], v[80:95]
    ds_read_b128 v[28:31], v167 offset:4096
    ds_read_b64_tr_b16 v[48:49], v176 offset:14336
    ds_read_b64_tr_b16 v[50:51], v176 offset:14848
    v_mfma_f32_32x32x16_bf16 v[96:111], v[16:19], v[36:39], v[96:111]
    ds_read_b64_tr_b16 v[52:53], v176 offset:22528
    ds_read_b64_tr_b16 v[54:55], v176 offset:23040
    v_mfma_f32_32x32x16_bf16 v[112:127], v[20:23], v[36:39], v[112:127]
    v_mfma_f32_32x32x16_bf16 v[128:143], v[16:19], v[40:43], v[128:143]
    v_mfma_f32_32x32x16_bf16 v[144:159], v[20:23], v[40:43], v[144:159]
    s_waitcnt lgkmcnt(0)
    v_mfma_f32_32x32x16_bf16 v[64:79], v[44:47], v[24:27], v[64:79]
    s_waitcnt vmcnt(0)
    s_barrier
    ds_read_b64_tr_b16 v[32:33], v11 offset:0
    ds_read_b64_tr_b16 v[34:35], v11 offset:512
    ds_read_b128 v[16:19], v6 offset:0
    v_mfma_f32_32x32x16_bf16 v[80:95], v[44:47], v[28:31], v[80:95]
    ds_read_b128 v[20:23], v6 offset:4096
    ds_read_b64_tr_b16 v[36:37], v11 offset:8192
    ds_read_b64_tr_b16 v[38:39], v11 offset:8704
    v_mfma_f32_32x32x16_bf16 v[96:111], v[24:27], v[48:51], v[96:111]
    ds_read_b64_tr_b16 v[40:41], v11 offset:16384
    ds_read_b64_tr_b16 v[42:43], v11 offset:16896
    v_mfma_f32_32x32x16_bf16 v[112:127], v[28:31], v[48:51], v[112:127]
    s_add_u32 s37, s39, 7
    s_and_b32 s37, s37, 15
    s_lshl_b32 s36, s37, 7
    s_mul_i32 s37, s37, 393216
    s_add_u32 m0, s31, 57344
    s_nop 0
    buffer_load_dwordx4 v204, s[12:15], s37 offen offset:0 lds
    v_mfma_f32_32x32x16_bf16 v[128:143], v[24:27], v[52:55], v[128:143]
    buffer_load_dwordx4 v205, s[12:15], s37 offen offset:1024 lds
    v_mfma_f32_32x32x16_bf16 v[144:159], v[28:31], v[52:55], v[144:159]
    buffer_load_dwordx4 v206, s[12:15], s37 offen offset:2048 lds
    s_add_u32 m0, s30, 57344
    s_nop 0
    buffer_load_dwordx4 v200, s[8:11], s36 offen offset:0 lds
    s_waitcnt lgkmcnt(0)
    v_mfma_f32_32x32x16_bf16 v[64:79], v[32:35], v[16:19], v[64:79]
    ds_read_b64_tr_b16 v[44:45], v11 offset:2048
    ds_read_b64_tr_b16 v[46:47], v11 offset:2560
    ds_read_b128 v[24:27], v7 offset:0
    v_mfma_f32_32x32x16_bf16 v[80:95], v[32:35], v[20:23], v[80:95]
    ds_read_b128 v[28:31], v7 offset:4096
    ds_read_b64_tr_b16 v[48:49], v11 offset:10240
    ds_read_b64_tr_b16 v[50:51], v11 offset:10752
    v_mfma_f32_32x32x16_bf16 v[96:111], v[16:19], v[36:39], v[96:111]
    ds_read_b64_tr_b16 v[52:53], v11 offset:18432
    ds_read_b64_tr_b16 v[54:55], v11 offset:18944
    v_mfma_f32_32x32x16_bf16 v[112:127], v[20:23], v[36:39], v[112:127]
    buffer_load_dwordx4 v201, s[8:11], s36 offen offset:1024 lds
    v_mfma_f32_32x32x16_bf16 v[128:143], v[16:19], v[40:43], v[128:143]
    buffer_load_dwordx4 v202, s[8:11], s36 offen offset:2048 lds
    v_mfma_f32_32x32x16_bf16 v[144:159], v[20:23], v[40:43], v[144:159]
    buffer_load_dwordx4 v203, s[8:11], s36 offen offset:3072 lds
    s_waitcnt lgkmcnt(0)
    v_mfma_f32_32x32x16_bf16 v[64:79], v[44:47], v[24:27], v[64:79]
    ds_read_b64_tr_b16 v[32:33], v11 offset:4096
    ds_read_b64_tr_b16 v[34:35], v11 offset:4608
    ds_read_b128 v[16:19], v8 offset:0
    v_mfma_f32_32x32x16_bf16 v[80:95], v[44:47], v[28:31], v[80:95]
    ds_read_b128 v[20:23], v8 offset:4096
    ds_read_b64_tr_b16 v[36:37], v11 offset:12288
    ds_read_b64_tr_b16 v[38:39], v11 offset:12800
    v_mfma_f32_32x32x16_bf16 v[96:111], v[24:27], v[48:51], v[96:111]
    ds_read_b64_tr_b16 v[40:41], v11 offset:20480
    ds_read_b64_tr_b16 v[42:43], v11 offset:20992
    v_mfma_f32_32x32x16_bf16 v[112:127], v[28:31], v[48:51], v[112:127]
    v_mfma_f32_32x32x16_bf16 v[128:143], v[24:27], v[52:55], v[128:143]
    v_mfma_f32_32x32x16_bf16 v[144:159], v[28:31], v[52:55], v[144:159]
    s_waitcnt lgkmcnt(0)
    v_mfma_f32_32x32x16_bf16 v[64:79], v[32:35], v[16:19], v[64:79]
    ds_read_b64_tr_b16 v[44:45], v11 offset:6144
    ds_read_b64_tr_b16 v[46:47], v11 offset:6656
    ds_read_b128 v[24:27], v9 offset:0
    v_mfma_f32_32x32x16_bf16 v[80:95], v[32:35], v[20:23], v[80:95]
    ds_read_b128 v[28:31], v9 offset:4096
    ds_read_b64_tr_b16 v[48:49], v11 offset:14336
    ds_read_b64_tr_b16 v[50:51], v11 offset:14848
    v_mfma_f32_32x32x16_bf16 v[96:111], v[16:19], v[36:39], v[96:111]
    ds_read_b64_tr_b16 v[52:53], v11 offset:22528
    ds_read_b64_tr_b16 v[54:55], v11 offset:23040
    v_mfma_f32_32x32x16_bf16 v[112:127], v[20:23], v[36:39], v[112:127]
    v_mfma_f32_32x32x16_bf16 v[128:143], v[16:19], v[40:43], v[128:143]
    v_mfma_f32_32x32x16_bf16 v[144:159], v[20:23], v[40:43], v[144:159]
    s_waitcnt lgkmcnt(0)
    v_mfma_f32_32x32x16_bf16 v[64:79], v[44:47], v[24:27], v[64:79]
    s_waitcnt vmcnt(0)
    s_barrier
    ds_read_b64_tr_b16 v[32:33], v176 offset:0
    ds_read_b64_tr_b16 v[34:35], v176 offset:512
    ds_read_b128 v[16:19], v164 offset:0
    v_mfma_f32_32x32x16_bf16 v[80:95], v[44:47], v[28:31], v[80:95]
    ds_read_b128 v[20:23], v164 offset:4096
    ds_read_b64_tr_b16 v[36:37], v176 offset:8192
    ds_read_b64_tr_b16 v[38:39], v176 offset:8704
    v_mfma_f32_32x32x16_bf16 v[96:111], v[24:27], v[48:51], v[96:111]
    ds_read_b64_tr_b16 v[40:41], v176 offset:16384
    ds_read_b64_tr_b16 v[42:43], v176 offset:16896
    v_mfma_f32_32x32x16_bf16 v[112:127], v[28:31], v[48:51], v[112:127]
    s_add_u32 s37, s39, 8
    s_and_b32 s37, s37, 15
    s_lshl_b32 s36, s37, 7
    s_mul_i32 s37, s37, 393216
    s_add_u32 m0, s31, 0
    s_nop 0
    buffer_load_dwordx4 v204, s[12:15], s37 offen offset:0 lds
    v_mfma_f32_32x32x16_bf16 v[128:143], v[24:27], v[52:55], v[128:143]
    buffer_load_dwordx4 v205, s[12:15], s37 offen offset:1024 lds
    v_mfma_f32_32x32x16_bf16 v[144:159], v[28:31], v[52:55], v[144:159]
    buffer_load_dwordx4 v206, s[12:15], s37 offen offset:2048 lds
    s_add_u32 m0, s30, 0
    s_nop 0
    buffer_load_dwordx4 v200, s[8:11], s36 offen offset:0 lds
    s_waitcnt lgkmcnt(0)
    v_mfma_f32_32x32x16_bf16 v[64:79], v[32:35], v[16:19], v[64:79]
    ds_read_b64_tr_b16 v[44:45], v176 offset:2048
    ds_read_b64_tr_b16 v[46:47], v176 offset:2560
    ds_read_b128 v[24:27], v165 offset:0
    v_mfma_f32_32x32x16_bf16 v[80:95], v[32:35], v[20:23], v[80:95]
    ds_read_b128 v[28:31], v165 offset:4096
    ds_read_b64_tr_b16 v[48:49], v176 offset:10240
    ds_read_b64_tr_b16 v[50:51], v176 offset:10752
    v_mfma_f32_32x32x16_bf16 v[96:111], v[16:19], v[36:39], v[96:111]
    ds_read_b64_tr_b16 v[52:53], v176 offset:18432
    ds_read_b64_tr_b16 v[54:55], v176 offset:18944
    v_mfma_f32_32x32x16_bf16 v[112:127], v[20:23], v[36:39], v[112:127]
    buffer_load_dwordx4 v201, s[8:11], s36 offen offset:1024 lds
    v_mfma_f32_32x32x16_bf16 v[128:143], v[16:19], v[40:43], v[128:143]
    buffer_load_dwordx4 v202, s[8:11], s36 offen offset:2048 lds
    v_mfma_f32_32x32x16_bf16 v[144:159], v[20:23], v[40:43], v[144:159]
    buffer_load_dwordx4 v203, s[8:11], s36 offen offset:3072 lds
    s_waitcnt lgkmcnt(0)
    v_mfma_f32_32x32x16_bf16 v[64:79], v[44:47], v[24:27], v[64:79]
    ds_read_b64_tr_b16 v[32:33], v176 offset:4096
    ds_read_b64_tr_b16 v[34:35], v176 offset:4608
    ds_read_b128 v[16:19], v166 offset:0
    v_mfma_f32_32x32x16_bf16 v[80:95], v[44:47], v[28:31], v[80:95]
    ds_read_b128 v[20:23], v166 offset:4096
    ds_read_b64_tr_b16 v[36:37], v176 offset:12288
    ds_read_b64_tr_b16 v[38:39], v176 offset:12800
    v_mfma_f32_32x32x16_bf16 v[96:111], v[24:27], v[48:51], v[96:111]
    ds_read_b64_tr_b16 v[40:41], v176 offset:20480
    ds_read_b64_tr_b16 v[42:43], v176 offset:20992
    v_mfma_f32_32x32x16_bf16 v[112:127], v[28:31], v[48:51], v[112:127]
    v_mfma_f32_32x32x16_bf16 v[128:143], v[24:27], v[52:55], v[128:143]
    v_mfma_f32_32x32x16_bf16 v[144:159], v[28:31], v[52:55], v[144:159]
    s_waitcnt lgkmcnt(0)
    v_mfma_f32_32x32x16_bf16 v[64:79], v[32:35], v[16:19], v[64:79]
    ds_read_b64_tr_b16 v[44:45], v176 offset:6144
    ds_read_b64_tr_b16 v[46:47], v176 offset:6656
    ds_read_b128 v[24:27], v167 offset:0
    v_mfma_f32_32x32x16_bf16 v[80:95], v[32:35], v[20:23], v[80:95]
    ds_read_b128 v[28:31], v167 offset:4096
    ds_read_b64_tr_b16 v[48:49], v176 offset:14336
    ds_read_b64_tr_b16 v[50:51], v176 offset:14848
    v_mfma_f32_32x32x16_bf16 v[96:111], v[16:19], v[36:39], v[96:111]
    ds_read_b64_tr_b16 v[52:53], v176 offset:22528
    ds_read_b64_tr_b16 v[54:55], v176 offset:23040
    v_mfma_f32_32x32x16_bf16 v[112:127], v[20:23], v[36:39], v[112:127]
    v_mfma_f32_32x32x16_bf16 v[128:143], v[16:19], v[40:43], v[128:143]
    v_mfma_f32_32x32x16_bf16 v[144:159], v[20:23], v[40:43], v[144:159]
    s_waitcnt lgkmcnt(0)
    v_mfma_f32_32x32x16_bf16 v[64:79], v[44:47], v[24:27], v[64:79]
    s_waitcnt vmcnt(0)
    s_barrier
    ds_read_b64_tr_b16 v[32:33], v11 offset:0
    ds_read_b64_tr_b16 v[34:35], v11 offset:512
    ds_read_b128 v[16:19], v6 offset:0
    v_mfma_f32_32x32x16_bf16 v[80:95], v[44:47], v[28:31], v[80:95]
    ds_read_b128 v[20:23], v6 offset:4096
    ds_read_b64_tr_b16 v[36:37], v11 offset:8192
    ds_read_b64_tr_b16 v[38:39], v11 offset:8704
    v_mfma_f32_32x32x16_bf16 v[96:111], v[24:27], v[48:51], v[96:111]
    ds_read_b64_tr_b16 v[40:41], v11 offset:16384
    ds_read_b64_tr_b16 v[42:43], v11 offset:16896
    v_mfma_f32_32x32x16_bf16 v[112:127], v[28:31], v[48:51], v[112:127]
    s_add_u32 s37, s39, 9
    s_and_b32 s37, s37, 15
    s_lshl_b32 s36, s37, 7
    s_mul_i32 s37, s37, 393216
    s_add_u32 m0, s31, 57344
    s_nop 0
    buffer_load_dwordx4 v204, s[12:15], s37 offen offset:0 lds
    v_mfma_f32_32x32x16_bf16 v[128:143], v[24:27], v[52:55], v[128:143]
    buffer_load_dwordx4 v205, s[12:15], s37 offen offset:1024 lds
    v_mfma_f32_32x32x16_bf16 v[144:159], v[28:31], v[52:55], v[144:159]
    buffer_load_dwordx4 v206, s[12:15], s37 offen offset:2048 lds
    s_add_u32 m0, s30, 57344
    s_nop 0
    buffer_load_dwordx4 v200, s[8:11], s36 offen offset:0 lds
    s_waitcnt lgkmcnt(0)
    v_mfma_f32_32x32x16_bf16 v[64:79], v[32:35], v[16:19], v[64:79]
    ds_read_b64_tr_b16 v[44:45], v11 offset:2048
    ds_read_b64_tr_b16 v[46:47], v11 offset:2560
    ds_read_b128 v[24:27], v7 offset:0
    v_mfma_f32_32x32x16_bf16 v[80:95], v[32:35], v[20:23], v[80:95]
    ds_read_b128 v[28:31], v7 offset:4096
    ds_read_b64_tr_b16 v[48:49], v11 offset:10240
    ds_read_b64_tr_b16 v[50:51], v11 offset:10752
    v_mfma_f32_32x32x16_bf16 v[96:111], v[16:19], v[36:39], v[96:111]
    ds_read_b64_tr_b16 v[52:53], v11 offset:18432
    ds_read_b64_tr_b16 v[54:55], v11 offset:18944
    v_mfma_f32_32x32x16_bf16 v[112:127], v[20:23], v[36:39], v[112:127]
    buffer_load_dwordx4 v201, s[8:11], s36 offen offset:1024 lds
    v_mfma_f32_32x32x16_bf16 v[128:143], v[16:19], v[40:43], v[128:143]
    buffer_load_dwordx4 v202, s[8:11], s36 offen offset:2048 lds
    v_mfma_f32_32x32x16_bf16 v[144:159], v[20:23], v[40:43], v[144:159]
    buffer_load_dwordx4 v203, s[8:11], s36 offen offset:3072 lds
    s_waitcnt lgkmcnt(0)
    v_mfma_f32_32x32x16_bf16 v[64:79], v[44:47], v[24:27], v[64:79]
    ds_read_b64_tr_b16 v[32:33], v11 offset:4096
    ds_read_b64_tr_b16 v[34:35], v11 offset:4608
    ds_read_b128 v[16:19], v8 offset:0
    v_mfma_f32_32x32x16_bf16 v[80:95], v[44:47], v[28:31], v[80:95]
    ds_read_b128 v[20:23], v8 offset:4096
    ds_read_b64_tr_b16 v[36:37], v11 offset:12288
    ds_read_b64_tr_b16 v[38:39], v11 offset:12800
    v_mfma_f32_32x32x16_bf16 v[96:111], v[24:27], v[48:51], v[96:111]
    ds_read_b64_tr_b16 v[40:41], v11 offset:20480
    ds_read_b64_tr_b16 v[42:43], v11 offset:20992
    v_mfma_f32_32x32x16_bf16 v[112:127], v[28:31], v[48:51], v[112:127]
    v_mfma_f32_32x32x16_bf16 v[128:143], v[24:27], v[52:55], v[128:143]
    v_mfma_f32_32x32x16_bf16 v[144:159], v[28:31], v[52:55], v[144:159]
    s_waitcnt lgkmcnt(0)
    v_mfma_f32_32x32x16_bf16 v[64:79], v[32:35], v[16:19], v[64:79]
    ds_read_b64_tr_b16 v[44:45], v11 offset:6144
    ds_read_b64_tr_b16 v[46:47], v11 offset:6656
    ds_read_b128 v[24:27], v9 offset:0
    v_mfma_f32_32x32x16_bf16 v[80:95], v[32:35], v[20:23], v[80:95]
    ds_read_b128 v[28:31], v9 offset:4096
    ds_read_b64_tr_b16 v[48:49], v11 offset:14336
    ds_read_b64_tr_b16 v[50:51], v11 offset:14848
    v_mfma_f32_32x32x16_bf16 v[96:111], v[16:19], v[36:39], v[96:111]
    ds_read_b64_tr_b16 v[52:53], v11 offset:22528
    ds_read_b64_tr_b16 v[54:55], v11 offset:23040
    v_mfma_f32_32x32x16_bf16 v[112:127], v[20:23], v[36:39], v[112:127]
    v_mfma_f32_32x32x16_bf16 v[128:143], v[16:19], v[40:43], v[128:143]
    v_mfma_f32_32x32x16_bf16 v[144:159], v[20:23], v[40:43], v[144:159]
    s_waitcnt lgkmcnt(0)
    v_mfma_f32_32x32x16_bf16 v[64:79], v[44:47], v[24:27], v[64:79]
    s_waitcnt vmcnt(0)
    s_barrier
    ds_read_b64_tr_b16 v[32:33], v176 offset:0
    ds_read_b64_tr_b16 v[34:35], v176 offset:512
    ds_read_b128 v[16:19], v164 offset:0
    v_mfma_f32_32x32x16_bf16 v[80:95], v[44:47], v[28:31], v[80:95]
    ds_read_b128 v[20:23], v164 offset:4096
    ds_read_b64_tr_b16 v[36:37], v176 offset:8192
    ds_read_b64_tr_b16 v[38:39], v176 offset:8704
    v_mfma_f32_32x32x16_bf16 v[96:111], v[24:27], v[48:51], v[96:111]
    ds_read_b64_tr_b16 v[40:41], v176 offset:16384
    ds_read_b64_tr_b16 v[42:43], v176 offset:16896
    v_mfma_f32_32x32x16_bf16 v[112:127], v[28:31], v[48:51], v[112:127]
    s_add_u32 s37, s39, 10
    s_and_b32 s37, s37, 15
    s_lshl_b32 s36, s37, 7
    s_mul_i32 s37, s37, 393216
    s_add_u32 m0, s31, 0
    s_nop 0
    buffer_load_dwordx4 v204, s[12:15], s37 offen offset:0 lds
    v_mfma_f32_32x32x16_bf16 v[128:143], v[24:27], v[52:55], v[128:143]
    buffer_load_dwordx4 v205, s[12:15], s37 offen offset:1024 lds
    v_mfma_f32_32x32x16_bf16 v[144:159], v[28:31], v[52:55], v[144:159]
    buffer_load_dwordx4 v206, s[12:15], s37 offen offset:2048 lds
    s_add_u32 m0, s30, 0
    s_nop 0
    buffer_load_dwordx4 v200, s[8:11], s36 offen offset:0 lds
    s_waitcnt lgkmcnt(0)
    v_mfma_f32_32x32x16_bf16 v[64:79], v[32:35], v[16:19], v[64:79]
    ds_read_b64_tr_b16 v[44:45], v176 offset:2048
    ds_read_b64_tr_b16 v[46:47], v176 offset:2560
    ds_read_b128 v[24:27], v165 offset:0
    v_mfma_f32_32x32x16_bf16 v[80:95], v[32:35], v[20:23], v[80:95]
    ds_read_b128 v[28:31], v165 offset:4096
    ds_read_b64_tr_b16 v[48:49], v176 offset:10240
    ds_read_b64_tr_b16 v[50:51], v176 offset:10752
    v_mfma_f32_32x32x16_bf16 v[96:111], v[16:19], v[36:39], v[96:111]
    ds_read_b64_tr_b16 v[52:53], v176 offset:18432
    ds_read_b64_tr_b16 v[54:55], v176 offset:18944
    v_mfma_f32_32x32x16_bf16 v[112:127], v[20:23], v[36:39], v[112:127]
    buffer_load_dwordx4 v201, s[8:11], s36 offen offset:1024 lds
    v_mfma_f32_32x32x16_bf16 v[128:143], v[16:19], v[40:43], v[128:143]
    buffer_load_dwordx4 v202, s[8:11], s36 offen offset:2048 lds
    v_mfma_f32_32x32x16_bf16 v[144:159], v[20:23], v[40:43], v[144:159]
    buffer_load_dwordx4 v203, s[8:11], s36 offen offset:3072 lds
    s_waitcnt lgkmcnt(0)
    v_mfma_f32_32x32x16_bf16 v[64:79], v[44:47], v[24:27], v[64:79]
    ds_read_b64_tr_b16 v[32:33], v176 offset:4096
    ds_read_b64_tr_b16 v[34:35], v176 offset:4608
    ds_read_b128 v[16:19], v166 offset:0
    v_mfma_f32_32x32x16_bf16 v[80:95], v[44:47], v[28:31], v[80:95]
    ds_read_b128 v[20:23], v166 offset:4096
    ds_read_b64_tr_b16 v[36:37], v176 offset:12288
    ds_read_b64_tr_b16 v[38:39], v176 offset:12800
    v_mfma_f32_32x32x16_bf16 v[96:111], v[24:27], v[48:51], v[96:111]
    ds_read_b64_tr_b16 v[40:41], v176 offset:20480
    ds_read_b64_tr_b16 v[42:43], v176 offset:20992
    v_mfma_f32_32x32x16_bf16 v[112:127], v[28:31], v[48:51], v[112:127]
    v_mfma_f32_32x32x16_bf16 v[128:143], v[24:27], v[52:55], v[128:143]
    v_mfma_f32_32x32x16_bf16 v[144:159], v[28:31], v[52:55], v[144:159]
    s_waitcnt lgkmcnt(0)
    v_mfma_f32_32x32x16_bf16 v[64:79], v[32:35], v[16:19], v[64:79]
    ds_read_b64_tr_b16 v[44:45], v176 offset:6144
    ds_read_b64_tr_b16 v[46:47], v176 offset:6656
    ds_read_b128 v[24:27], v167 offset:0
    v_mfma_f32_32x32x16_bf16 v[80:95], v[32:35], v[20:23], v[80:95]
    ds_read_b128 v[28:31], v167 offset:4096
    ds_read_b64_tr_b16 v[48:49], v176 offset:14336
    ds_read_b64_tr_b16 v[50:51], v176 offset:14848
    v_mfma_f32_32x32x16_bf16 v[96:111], v[16:19], v[36:39], v[96:111]
    ds_read_b64_tr_b16 v[52:53], v176 offset:22528
    ds_read_b64_tr_b16 v[54:55], v176 offset:23040
    v_mfma_f32_32x32x16_bf16 v[112:127], v[20:23], v[36:39], v[112:127]
    v_mfma_f32_32x32x16_bf16 v[128:143], v[16:19], v[40:43], v[128:143]
    v_mfma_f32_32x32x16_bf16 v[144:159], v[20:23], v[40:43], v[144:159]
    s_waitcnt lgkmcnt(0)
    v_mfma_f32_32x32x16_bf16 v[64:79], v[44:47], v[24:27], v[64:79]
    s_waitcnt vmcnt(0)
    s_barrier
    ds_read_b64_tr_b16 v[32:33], v11 offset:0
    ds_read_b64_tr_b16 v[34:35], v11 offset:512
    ds_read_b128 v[16:19], v6 offset:0
    v_mfma_f32_32x32x16_bf16 v[80:95], v[44:47], v[28:31], v[80:95]
    ds_read_b128 v[20:23], v6 offset:4096
    ds_read_b64_tr_b16 v[36:37], v11 offset:8192
    ds_read_b64_tr_b16 v[38:39], v11 offset:8704
    v_mfma_f32_32x32x16_bf16 v[96:111], v[24:27], v[48:51], v[96:111]
    ds_read_b64_tr_b16 v[40:41], v11 offset:16384
    ds_read_b64_tr_b16 v[42:43], v11 offset:16896
    v_mfma_f32_32x32x16_bf16 v[112:127], v[28:31], v[48:51], v[112:127]
    s_add_u32 s37, s39, 11
    s_and_b32 s37, s37, 15
    s_lshl_b32 s36, s37, 7
    s_mul_i32 s37, s37, 393216
    s_add_u32 m0, s31, 57344
    s_nop 0
    buffer_load_dwordx4 v204, s[12:15], s37 offen offset:0 lds
    v_mfma_f32_32x32x16_bf16 v[128:143], v[24:27], v[52:55], v[128:143]
    buffer_load_dwordx4 v205, s[12:15], s37 offen offset:1024 lds
    v_mfma_f32_32x32x16_bf16 v[144:159], v[28:31], v[52:55], v[144:159]
    buffer_load_dwordx4 v206, s[12:15], s37 offen offset:2048 lds
    s_add_u32 m0, s30, 57344
    s_nop 0
    buffer_load_dwordx4 v200, s[8:11], s36 offen offset:0 lds
    s_waitcnt lgkmcnt(0)
    v_mfma_f32_32x32x16_bf16 v[64:79], v[32:35], v[16:19], v[64:79]
    ds_read_b64_tr_b16 v[44:45], v11 offset:2048
    ds_read_b64_tr_b16 v[46:47], v11 offset:2560
    ds_read_b128 v[24:27], v7 offset:0
    v_mfma_f32_32x32x16_bf16 v[80:95], v[32:35], v[20:23], v[80:95]
    ds_read_b128 v[28:31], v7 offset:4096
    ds_read_b64_tr_b16 v[48:49], v11 offset:10240
    ds_read_b64_tr_b16 v[50:51], v11 offset:10752
    v_mfma_f32_32x32x16_bf16 v[96:111], v[16:19], v[36:39], v[96:111]
    ds_read_b64_tr_b16 v[52:53], v11 offset:18432
    ds_read_b64_tr_b16 v[54:55], v11 offset:18944
    v_mfma_f32_32x32x16_bf16 v[112:127], v[20:23], v[36:39], v[112:127]
    buffer_load_dwordx4 v201, s[8:11], s36 offen offset:1024 lds
    v_mfma_f32_32x32x16_bf16 v[128:143], v[16:19], v[40:43], v[128:143]
    buffer_load_dwordx4 v202, s[8:11], s36 offen offset:2048 lds
    v_mfma_f32_32x32x16_bf16 v[144:159], v[20:23], v[40:43], v[144:159]
    buffer_load_dwordx4 v203, s[8:11], s36 offen offset:3072 lds
    s_waitcnt lgkmcnt(0)
    v_mfma_f32_32x32x16_bf16 v[64:79], v[44:47], v[24:27], v[64:79]
    ds_read_b64_tr_b16 v[32:33], v11 offset:4096
    ds_read_b64_tr_b16 v[34:35], v11 offset:4608
    ds_read_b128 v[16:19], v8 offset:0
    v_mfma_f32_32x32x16_bf16 v[80:95], v[44:47], v[28:31], v[80:95]
    ds_read_b128 v[20:23], v8 offset:4096
    ds_read_b64_tr_b16 v[36:37], v11 offset:12288
    ds_read_b64_tr_b16 v[38:39], v11 offset:12800
    v_mfma_f32_32x32x16_bf16 v[96:111], v[24:27], v[48:51], v[96:111]
    ds_read_b64_tr_b16 v[40:41], v11 offset:20480
    ds_read_b64_tr_b16 v[42:43], v11 offset:20992
    v_mfma_f32_32x32x16_bf16 v[112:127], v[28:31], v[48:51], v[112:127]
    v_mfma_f32_32x32x16_bf16 v[128:143], v[24:27], v[52:55], v[128:143]
    v_mfma_f32_32x32x16_bf16 v[144:159], v[28:31], v[52:55], v[144:159]
    s_waitcnt lgkmcnt(0)
    v_mfma_f32_32x32x16_bf16 v[64:79], v[32:35], v[16:19], v[64:79]
    ds_read_b64_tr_b16 v[44:45], v11 offset:6144
    ds_read_b64_tr_b16 v[46:47], v11 offset:6656
    ds_read_b128 v[24:27], v9 offset:0
    v_mfma_f32_32x32x16_bf16 v[80:95], v[32:35], v[20:23], v[80:95]
    ds_read_b128 v[28:31], v9 offset:4096
    ds_read_b64_tr_b16 v[48:49], v11 offset:14336
    ds_read_b64_tr_b16 v[50:51], v11 offset:14848
    v_mfma_f32_32x32x16_bf16 v[96:111], v[16:19], v[36:39], v[96:111]
    ds_read_b64_tr_b16 v[52:53], v11 offset:22528
    ds_read_b64_tr_b16 v[54:55], v11 offset:23040
    v_mfma_f32_32x32x16_bf16 v[112:127], v[20:23], v[36:39], v[112:127]
    v_mfma_f32_32x32x16_bf16 v[128:143], v[16:19], v[40:43], v[128:143]
    v_mfma_f32_32x32x16_bf16 v[144:159], v[20:23], v[40:43], v[144:159]
    s_waitcnt lgkmcnt(0)
    v_mfma_f32_32x32x16_bf16 v[64:79], v[44:47], v[24:27], v[64:79]
    s_waitcnt vmcnt(0)
    s_barrier
    ds_read_b64_tr_b16 v[32:33], v176 offset:0
    ds_read_b64_tr_b16 v[34:35], v176 offset:512
    ds_read_b128 v[16:19], v164 offset:0
    v_mfma_f32_32x32x16_bf16 v[80:95], v[44:47], v[28:31], v[80:95]
    ds_read_b128 v[20:23], v164 offset:4096
    ds_read_b64_tr_b16 v[36:37], v176 offset:8192
    ds_read_b64_tr_b16 v[38:39], v176 offset:8704
    v_mfma_f32_32x32x16_bf16 v[96:111], v[24:27], v[48:51], v[96:111]
    ds_read_b64_tr_b16 v[40:41], v176 offset:16384
    ds_read_b64_tr_b16 v[42:43], v176 offset:16896
    v_mfma_f32_32x32x16_bf16 v[112:127], v[28:31], v[48:51], v[112:127]
    s_add_u32 s37, s39, 12
    s_and_b32 s37, s37, 15
    s_lshl_b32 s36, s37, 7
    s_mul_i32 s37, s37, 393216
    s_add_u32 m0, s31, 0
    s_nop 0
    buffer_load_dwordx4 v204, s[12:15], s37 offen offset:0 lds
    v_mfma_f32_32x32x16_bf16 v[128:143], v[24:27], v[52:55], v[128:143]
    buffer_load_dwordx4 v205, s[12:15], s37 offen offset:1024 lds
    v_mfma_f32_32x32x16_bf16 v[144:159], v[28:31], v[52:55], v[144:159]
    buffer_load_dwordx4 v206, s[12:15], s37 offen offset:2048 lds
    s_add_u32 m0, s30, 0
    s_nop 0
    buffer_load_dwordx4 v200, s[8:11], s36 offen offset:0 lds
    s_waitcnt lgkmcnt(0)
    v_mfma_f32_32x32x16_bf16 v[64:79], v[32:35], v[16:19], v[64:79]
    ds_read_b64_tr_b16 v[44:45], v176 offset:2048
    ds_read_b64_tr_b16 v[46:47], v176 offset:2560
    ds_read_b128 v[24:27], v165 offset:0
    v_mfma_f32_32x32x16_bf16 v[80:95], v[32:35], v[20:23], v[80:95]
    ds_read_b128 v[28:31], v165 offset:4096
    ds_read_b64_tr_b16 v[48:49], v176 offset:10240
    ds_read_b64_tr_b16 v[50:51], v176 offset:10752
    v_mfma_f32_32x32x16_bf16 v[96:111], v[16:19], v[36:39], v[96:111]
    ds_read_b64_tr_b16 v[52:53], v176 offset:18432
    ds_read_b64_tr_b16 v[54:55], v176 offset:18944
    v_mfma_f32_32x32x16_bf16 v[112:127], v[20:23], v[36:39], v[112:127]
    buffer_load_dwordx4 v201, s[8:11], s36 offen offset:1024 lds
    v_mfma_f32_32x32x16_bf16 v[128:143], v[16:19], v[40:43], v[128:143]
    buffer_load_dwordx4 v202, s[8:11], s36 offen offset:2048 lds
    v_mfma_f32_32x32x16_bf16 v[144:159], v[20:23], v[40:43], v[144:159]
    buffer_load_dwordx4 v203, s[8:11], s36 offen offset:3072 lds
    s_waitcnt lgkmcnt(0)
    v_mfma_f32_32x32x16_bf16 v[64:79], v[44:47], v[24:27], v[64:79]
    ds_read_b64_tr_b16 v[32:33], v176 offset:4096
    ds_read_b64_tr_b16 v[34:35], v176 offset:4608
    ds_read_b128 v[16:19], v166 offset:0
    v_mfma_f32_32x32x16_bf16 v[80:95], v[44:47], v[28:31], v[80:95]
    ds_read_b128 v[20:23], v166 offset:4096
    ds_read_b64_tr_b16 v[36:37], v176 offset:12288
    ds_read_b64_tr_b16 v[38:39], v176 offset:12800
    v_mfma_f32_32x32x16_bf16 v[96:111], v[24:27], v[48:51], v[96:111]
    ds_read_b64_tr_b16 v[40:41], v176 offset:20480
    ds_read_b64_tr_b16 v[42:43], v176 offset:20992
    v_mfma_f32_32x32x16_bf16 v[112:127], v[28:31], v[48:51], v[112:127]
    v_mfma_f32_32x32x16_bf16 v[128:143], v[24:27], v[52:55], v[128:143]
    v_mfma_f32_32x32x16_bf16 v[144:159], v[28:31], v[52:55], v[144:159]
    s_waitcnt lgkmcnt(0)
    v_mfma_f32_32x32x16_bf16 v[64:79], v[32:35], v[16:19], v[64:79]
    ds_read_b64_tr_b16 v[44:45], v176 offset:6144
    ds_read_b64_tr_b16 v[46:47], v176 offset:6656
    ds_read_b128 v[24:27], v167 offset:0
    v_mfma_f32_32x32x16_bf16 v[80:95], v[32:35], v[20:23], v[80:95]
    ds_read_b128 v[28:31], v167 offset:4096
    ds_read_b64_tr_b16 v[48:49], v176 offset:14336
    ds_read_b64_tr_b16 v[50:51], v176 offset:14848
    v_mfma_f32_32x32x16_bf16 v[96:111], v[16:19], v[36:39], v[96:111]
    ds_read_b64_tr_b16 v[52:53], v176 offset:22528
    ds_read_b64_tr_b16 v[54:55], v176 offset:23040
    v_mfma_f32_32x32x16_bf16 v[112:127], v[20:23], v[36:39], v[112:127]
    v_mfma_f32_32x32x16_bf16 v[128:143], v[16:19], v[40:43], v[128:143]
    v_mfma_f32_32x32x16_bf16 v[144:159], v[20:23], v[40:43], v[144:159]
    s_waitcnt lgkmcnt(0)
    v_mfma_f32_32x32x16_bf16 v[64:79], v[44:47], v[24:27], v[64:79]
    s_waitcnt vmcnt(0)
    s_barrier
    ds_read_b64_tr_b16 v[32:33], v11 offset:0
    ds_read_b64_tr_b16 v[34:35], v11 offset:512
    ds_read_b128 v[16:19], v6 offset:0
    v_mfma_f32_32x32x16_bf16 v[80:95], v[44:47], v[28:31], v[80:95]
    ds_read_b128 v[20:23], v6 offset:4096
    ds_read_b64_tr_b16 v[36:37], v11 offset:8192
    ds_read_b64_tr_b16 v[38:39], v11 offset:8704
    v_mfma_f32_32x32x16_bf16 v[96:111], v[24:27], v[48:51], v[96:111]
    ds_read_b64_tr_b16 v[40:41], v11 offset:16384
    ds_read_b64_tr_b16 v[42:43], v11 offset:16896
    v_mfma_f32_32x32x16_bf16 v[112:127], v[28:31], v[48:51], v[112:127]
    s_add_u32 s37, s39, 13
    s_and_b32 s37, s37, 15
    s_lshl_b32 s36, s37, 7
    s_mul_i32 s37, s37, 393216
    s_add_u32 m0, s31, 57344
    s_nop 0
    buffer_load_dwordx4 v204, s[12:15], s37 offen offset:0 lds
    v_mfma_f32_32x32x16_bf16 v[128:143], v[24:27], v[52:55], v[128:143]
    buffer_load_dwordx4 v205, s[12:15], s37 offen offset:1024 lds
    v_mfma_f32_32x32x16_bf16 v[144:159], v[28:31], v[52:55], v[144:159]
    buffer_load_dwordx4 v206, s[12:15], s37 offen offset:2048 lds
    s_add_u32 m0, s30, 57344
    s_nop 0
    buffer_load_dwordx4 v200, s[8:11], s36 offen offset:0 lds
    s_waitcnt lgkmcnt(0)
    v_mfma_f32_32x32x16_bf16 v[64:79], v[32:35], v[16:19], v[64:79]
    ds_read_b64_tr_b16 v[44:45], v11 offset:2048
    ds_read_b64_tr_b16 v[46:47], v11 offset:2560
    ds_read_b128 v[24:27], v7 offset:0
    v_mfma_f32_32x32x16_bf16 v[80:95], v[32:35], v[20:23], v[80:95]
    ds_read_b128 v[28:31], v7 offset:4096
    ds_read_b64_tr_b16 v[48:49], v11 offset:10240
    ds_read_b64_tr_b16 v[50:51], v11 offset:10752
    v_mfma_f32_32x32x16_bf16 v[96:111], v[16:19], v[36:39], v[96:111]
    ds_read_b64_tr_b16 v[52:53], v11 offset:18432
    ds_read_b64_tr_b16 v[54:55], v11 offset:18944
    v_mfma_f32_32x32x16_bf16 v[112:127], v[20:23], v[36:39], v[112:127]
    buffer_load_dwordx4 v201, s[8:11], s36 offen offset:1024 lds
    v_mfma_f32_32x32x16_bf16 v[128:143], v[16:19], v[40:43], v[128:143]
    buffer_load_dwordx4 v202, s[8:11], s36 offen offset:2048 lds
    v_mfma_f32_32x32x16_bf16 v[144:159], v[20:23], v[40:43], v[144:159]
    buffer_load_dwordx4 v203, s[8:11], s36 offen offset:3072 lds
    s_waitcnt lgkmcnt(0)
    v_mfma_f32_32x32x16_bf16 v[64:79], v[44:47], v[24:27], v[64:79]
    ds_read_b64_tr_b16 v[32:33], v11 offset:4096
    ds_read_b64_tr_b16 v[34:35], v11 offset:4608
    ds_read_b128 v[16:19], v8 offset:0
    v_mfma_f32_32x32x16_bf16 v[80:95], v[44:47], v[28:31], v[80:95]
    ds_read_b128 v[20:23], v8 offset:4096
    ds_read_b64_tr_b16 v[36:37], v11 offset:12288
    ds_read_b64_tr_b16 v[38:39], v11 offset:12800
    v_mfma_f32_32x32x16_bf16 v[96:111], v[24:27], v[48:51], v[96:111]
    ds_read_b64_tr_b16 v[40:41], v11 offset:20480
    ds_read_b64_tr_b16 v[42:43], v11 offset:20992
    v_mfma_f32_32x32x16_bf16 v[112:127], v[28:31], v[48:51], v[112:127]
    v_mfma_f32_32x32x16_bf16 v[128:143], v[24:27], v[52:55], v[128:143]
    v_mfma_f32_32x32x16_bf16 v[144:159], v[28:31], v[52:55], v[144:159]
    s_waitcnt lgkmcnt(0)
    v_mfma_f32_32x32x16_bf16 v[64:79], v[32:35], v[16:19], v[64:79]
    ds_read_b64_tr_b16 v[44:45], v11 offset:6144
    ds_read_b64_tr_b16 v[46:47], v11 offset:6656
    ds_read_b128 v[24:27], v9 offset:0
    v_mfma_f32_32x32x16_bf16 v[80:95], v[32:35], v[20:23], v[80:95]
    ds_read_b128 v[28:31], v9 offset:4096
    ds_read_b64_tr_b16 v[48:49], v11 offset:14336
    ds_read_b64_tr_b16 v[50:51], v11 offset:14848
    v_mfma_f32_32x32x16_bf16 v[96:111], v[16:19], v[36:39], v[96:111]
    ds_read_b64_tr_b16 v[52:53], v11 offset:22528
    ds_read_b64_tr_b16 v[54:55], v11 offset:23040
    v_mfma_f32_32x32x16_bf16 v[112:127], v[20:23], v[36:39], v[112:127]
    v_mfma_f32_32x32x16_bf16 v[128:143], v[16:19], v[40:43], v[128:143]
    v_mfma_f32_32x32x16_bf16 v[144:159], v[20:23], v[40:43], v[144:159]
    s_waitcnt lgkmcnt(0)
    v_mfma_f32_32x32x16_bf16 v[64:79], v[44:47], v[24:27], v[64:79]
    s_waitcnt vmcnt(0)
    s_barrier
    ds_read_b64_tr_b16 v[32:33], v176 offset:0
    ds_read_b64_tr_b16 v[34:35], v176 offset:512
    ds_read_b128 v[16:19], v164 offset:0
    v_mfma_f32_32x32x16_bf16 v[80:95], v[44:47], v[28:31], v[80:95]
    ds_read_b128 v[20:23], v164 offset:4096
    ds_read_b64_tr_b16 v[36:37], v176 offset:8192
    ds_read_b64_tr_b16 v[38:39], v176 offset:8704
    v_mfma_f32_32x32x16_bf16 v[96:111], v[24:27], v[48:51], v[96:111]
    ds_read_b64_tr_b16 v[40:41], v176 offset:16384
    ds_read_b64_tr_b16 v[42:43], v176 offset:16896
    v_mfma_f32_32x32x16_bf16 v[112:127], v[28:31], v[48:51], v[112:127]
    s_add_u32 s37, s39, 14
    s_and_b32 s37, s37, 15
    s_lshl_b32 s36, s37, 7
    s_mul_i32 s37, s37, 393216
    s_add_u32 m0, s31, 0
    s_nop 0
    buffer_load_dwordx4 v204, s[12:15], s37 offen offset:0 lds
    v_mfma_f32_32x32x16_bf16 v[128:143], v[24:27], v[52:55], v[128:143]
    buffer_load_dwordx4 v205, s[12:15], s37 offen offset:1024 lds
    v_mfma_f32_32x32x16_bf16 v[144:159], v[28:31], v[52:55], v[144:159]
    buffer_load_dwordx4 v206, s[12:15], s37 offen offset:2048 lds
    s_add_u32 m0, s30, 0
    s_nop 0
    buffer_load_dwordx4 v200, s[8:11], s36 offen offset:0 lds
    s_waitcnt lgkmcnt(0)
    v_mfma_f32_32x32x16_bf16 v[64:79], v[32:35], v[16:19], v[64:79]
    ds_read_b64_tr_b16 v[44:45], v176 offset:2048
    ds_read_b64_tr_b16 v[46:47], v176 offset:2560
    ds_read_b128 v[24:27], v165 offset:0
    v_mfma_f32_32x32x16_bf16 v[80:95], v[32:35], v[20:23], v[80:95]
    ds_read_b128 v[28:31], v165 offset:4096
    ds_read_b64_tr_b16 v[48:49], v176 offset:10240
    ds_read_b64_tr_b16 v[50:51], v176 offset:10752
    v_mfma_f32_32x32x16_bf16 v[96:111], v[16:19], v[36:39], v[96:111]
    ds_read_b64_tr_b16 v[52:53], v176 offset:18432
    ds_read_b64_tr_b16 v[54:55], v176 offset:18944
    v_mfma_f32_32x32x16_bf16 v[112:127], v[20:23], v[36:39], v[112:127]
    buffer_load_dwordx4 v201, s[8:11], s36 offen offset:1024 lds
    v_mfma_f32_32x32x16_bf16 v[128:143], v[16:19], v[40:43], v[128:143]
    buffer_load_dwordx4 v202, s[8:11], s36 offen offset:2048 lds
    v_mfma_f32_32x32x16_bf16 v[144:159], v[20:23], v[40:43], v[144:159]
    buffer_load_dwordx4 v203, s[8:11], s36 offen offset:3072 lds
    s_waitcnt lgkmcnt(0)
    v_mfma_f32_32x32x16_bf16 v[64:79], v[44:47], v[24:27], v[64:79]
    ds_read_b64_tr_b16 v[32:33], v176 offset:4096
    ds_read_b64_tr_b16 v[34:35], v176 offset:4608
    ds_read_b128 v[16:19], v166 offset:0
    v_mfma_f32_32x32x16_bf16 v[80:95], v[44:47], v[28:31], v[80:95]
    ds_read_b128 v[20:23], v166 offset:4096
    ds_read_b64_tr_b16 v[36:37], v176 offset:12288
    ds_read_b64_tr_b16 v[38:39], v176 offset:12800
    v_mfma_f32_32x32x16_bf16 v[96:111], v[24:27], v[48:51], v[96:111]
    ds_read_b64_tr_b16 v[40:41], v176 offset:20480
    ds_read_b64_tr_b16 v[42:43], v176 offset:20992
    v_mfma_f32_32x32x16_bf16 v[112:127], v[28:31], v[48:51], v[112:127]
    v_mfma_f32_32x32x16_bf16 v[128:143], v[24:27], v[52:55], v[128:143]
    v_mfma_f32_32x32x16_bf16 v[144:159], v[28:31], v[52:55], v[144:159]
    s_waitcnt lgkmcnt(0)
    v_mfma_f32_32x32x16_bf16 v[64:79], v[32:35], v[16:19], v[64:79]
    ds_read_b64_tr_b16 v[44:45], v176 offset:6144
    ds_read_b64_tr_b16 v[46:47], v176 offset:6656
    ds_read_b128 v[24:27], v167 offset:0
    v_mfma_f32_32x32x16_bf16 v[80:95], v[32:35], v[20:23], v[80:95]
    ds_read_b128 v[28:31], v167 offset:4096
    ds_read_b64_tr_b16 v[48:49], v176 offset:14336
    ds_read_b64_tr_b16 v[50:51], v176 offset:14848
    v_mfma_f32_32x32x16_bf16 v[96:111], v[16:19], v[36:39], v[96:111]
    ds_read_b64_tr_b16 v[52:53], v176 offset:22528
    ds_read_b64_tr_b16 v[54:55], v176 offset:23040
    v_mfma_f32_32x32x16_bf16 v[112:127], v[20:23], v[36:39], v[112:127]
    v_mfma_f32_32x32x16_bf16 v[128:143], v[16:19], v[40:43], v[128:143]
    v_mfma_f32_32x32x16_bf16 v[144:159], v[20:23], v[40:43], v[144:159]
    s_waitcnt lgkmcnt(0)
    v_mfma_f32_32x32x16_bf16 v[64:79], v[44:47], v[24:27], v[64:79]
    s_waitcnt vmcnt(0)
    s_barrier
    ds_read_b64_tr_b16 v[32:33], v11 offset:0
    ds_read_b64_tr_b16 v[34:35], v11 offset:512
    ds_read_b128 v[16:19], v6 offset:0
    v_mfma_f32_32x32x16_bf16 v[80:95], v[44:47], v[28:31], v[80:95]
    ds_read_b128 v[20:23], v6 offset:4096
    ds_read_b64_tr_b16 v[36:37], v11 offset:8192
    ds_read_b64_tr_b16 v[38:39], v11 offset:8704
    v_mfma_f32_32x32x16_bf16 v[96:111], v[24:27], v[48:51], v[96:111]
    ds_read_b64_tr_b16 v[40:41], v11 offset:16384
    ds_read_b64_tr_b16 v[42:43], v11 offset:16896
    v_mfma_f32_32x32x16_bf16 v[112:127], v[28:31], v[48:51], v[112:127]
    s_add_u32 s37, s39, 15
    s_and_b32 s37, s37, 15
    s_lshl_b32 s36, s37, 7
    s_mul_i32 s37, s37, 393216
    s_add_u32 m0, s31, 57344
    s_nop 0
    buffer_load_dwordx4 v204, s[12:15], s37 offen offset:0 lds
    v_mfma_f32_32x32x16_bf16 v[128:143], v[24:27], v[52:55], v[128:143]
    buffer_load_dwordx4 v205, s[12:15], s37 offen offset:1024 lds
    v_mfma_f32_32x32x16_bf16 v[144:159], v[28:31], v[52:55], v[144:159]
    buffer_load_dwordx4 v206, s[12:15], s37 offen offset:2048 lds
    s_add_u32 m0, s30, 57344
    s_nop 0
    buffer_load_dwordx4 v200, s[8:11], s36 offen offset:0 lds
    s_waitcnt lgkmcnt(0)
    v_mfma_f32_32x32x16_bf16 v[64:79], v[32:35], v[16:19], v[64:79]
    ds_read_b64_tr_b16 v[44:45], v11 offset:2048
    ds_read_b64_tr_b16 v[46:47], v11 offset:2560
    ds_read_b128 v[24:27], v7 offset:0
    v_mfma_f32_32x32x16_bf16 v[80:95], v[32:35], v[20:23], v[80:95]
    ds_read_b128 v[28:31], v7 offset:4096
    ds_read_b64_tr_b16 v[48:49], v11 offset:10240
    ds_read_b64_tr_b16 v[50:51], v11 offset:10752
    v_mfma_f32_32x32x16_bf16 v[96:111], v[16:19], v[36:39], v[96:111]
    ds_read_b64_tr_b16 v[52:53], v11 offset:18432
    ds_read_b64_tr_b16 v[54:55], v11 offset:18944
    v_mfma_f32_32x32x16_bf16 v[112:127], v[20:23], v[36:39], v[112:127]
    buffer_load_dwordx4 v201, s[8:11], s36 offen offset:1024 lds
    v_mfma_f32_32x32x16_bf16 v[128:143], v[16:19], v[40:43], v[128:143]
    buffer_load_dwordx4 v202, s[8:11], s36 offen offset:2048 lds
    v_mfma_f32_32x32x16_bf16 v[144:159], v[20:23], v[40:43], v[144:159]
    buffer_load_dwordx4 v203, s[8:11], s36 offen offset:3072 lds
    s_waitcnt lgkmcnt(0)
    v_mfma_f32_32x32x16_bf16 v[64:79], v[44:47], v[24:27], v[64:79]
    ds_read_b64_tr_b16 v[32:33], v11 offset:4096
    ds_read_b64_tr_b16 v[34:35], v11 offset:4608
    ds_read_b128 v[16:19], v8 offset:0
    v_mfma_f32_32x32x16_bf16 v[80:95], v[44:47], v[28:31], v[80:95]
    ds_read_b128 v[20:23], v8 offset:4096
    ds_read_b64_tr_b16 v[36:37], v11 offset:12288
    ds_read_b64_tr_b16 v[38:39], v11 offset:12800
    v_mfma_f32_32x32x16_bf16 v[96:111], v[24:27], v[48:51], v[96:111]
    ds_read_b64_tr_b16 v[40:41], v11 offset:20480
    ds_read_b64_tr_b16 v[42:43], v11 offset:20992
    v_mfma_f32_32x32x16_bf16 v[112:127], v[28:31], v[48:51], v[112:127]
    v_mfma_f32_32x32x16_bf16 v[128:143], v[24:27], v[52:55], v[128:143]
    v_mfma_f32_32x32x16_bf16 v[144:159], v[28:31], v[52:55], v[144:159]
    s_waitcnt lgkmcnt(0)
    v_mfma_f32_32x32x16_bf16 v[64:79], v[32:35], v[16:19], v[64:79]
    ds_read_b64_tr_b16 v[44:45], v11 offset:6144
    ds_read_b64_tr_b16 v[46:47], v11 offset:6656
    ds_read_b128 v[24:27], v9 offset:0
    v_mfma_f32_32x32x16_bf16 v[80:95], v[32:35], v[20:23], v[80:95]
    ds_read_b128 v[28:31], v9 offset:4096
    ds_read_b64_tr_b16 v[48:49], v11 offset:14336
    ds_read_b64_tr_b16 v[50:51], v11 offset:14848
    v_mfma_f32_32x32x16_bf16 v[96:111], v[16:19], v[36:39], v[96:111]
    ds_read_b64_tr_b16 v[52:53], v11 offset:22528
    ds_read_b64_tr_b16 v[54:55], v11 offset:23040
    v_mfma_f32_32x32x16_bf16 v[112:127], v[20:23], v[36:39], v[112:127]
    v_mfma_f32_32x32x16_bf16 v[128:143], v[16:19], v[40:43], v[128:143]
    v_mfma_f32_32x32x16_bf16 v[144:159], v[20:23], v[40:43], v[144:159]
    s_waitcnt lgkmcnt(0)
    v_mfma_f32_32x32x16_bf16 v[64:79], v[44:47], v[24:27], v[64:79]
    s_waitcnt vmcnt(0)
    s_barrier
    ds_read_b64_tr_b16 v[32:33], v176 offset:0
    ds_read_b64_tr_b16 v[34:35], v176 offset:512
    ds_read_b128 v[16:19], v164 offset:0
    v_mfma_f32_32x32x16_bf16 v[80:95], v[44:47], v[28:31], v[80:95]
    ds_read_b128 v[20:23], v164 offset:4096
    ds_read_b64_tr_b16 v[36:37], v176 offset:8192
    ds_read_b64_tr_b16 v[38:39], v176 offset:8704
    v_mfma_f32_32x32x16_bf16 v[96:111], v[24:27], v[48:51], v[96:111]
    ds_read_b64_tr_b16 v[40:41], v176 offset:16384
    ds_read_b64_tr_b16 v[42:43], v176 offset:16896
    v_mfma_f32_32x32x16_bf16 v[112:127], v[28:31], v[48:51], v[112:127]
    v_mfma_f32_32x32x16_bf16 v[128:143], v[24:27], v[52:55], v[128:143]
    v_mfma_f32_32x32x16_bf16 v[144:159], v[28:31], v[52:55], v[144:159]
    s_waitcnt lgkmcnt(0)
    v_mfma_f32_32x32x16_bf16 v[64:79], v[32:35], v[16:19], v[64:79]
    ds_read_b64_tr_b16 v[44:45], v176 offset:2048
    ds_read_b64_tr_b16 v[46:47], v176 offset:2560
    ds_read_b128 v[24:27], v165 offset:0
    v_mfma_f32_32x32x16_bf16 v[80:95], v[32:35], v[20:23], v[80:95]
    ds_read_b128 v[28:31], v165 offset:4096
    ds_read_b64_tr_b16 v[48:49], v176 offset:10240
    ds_read_b64_tr_b16 v[50:51], v176 offset:10752
    v_mfma_f32_32x32x16_bf16 v[96:111], v[16:19], v[36:39], v[96:111]
    ds_read_b64_tr_b16 v[52:53], v176 offset:18432
    ds_read_b64_tr_b16 v[54:55], v176 offset:18944
    v_mfma_f32_32x32x16_bf16 v[112:127], v[20:23], v[36:39], v[112:127]
    v_mfma_f32_32x32x16_bf16 v[128:143], v[16:19], v[40:43], v[128:143]
    v_mfma_f32_32x32x16_bf16 v[144:159], v[20:23], v[40:43], v[144:159]
    s_waitcnt lgkmcnt(0)
    v_mfma_f32_32x32x16_bf16 v[64:79], v[44:47], v[24:27], v[64:79]
    ds_read_b64_tr_b16 v[32:33], v176 offset:4096
    ds_read_b64_tr_b16 v[34:35], v176 offset:4608
    ds_read_b128 v[16:19], v166 offset:0
    v_mfma_f32_32x32x16_bf16 v[80:95], v[44:47], v[28:31], v[80:95]
    ds_read_b128 v[20:23], v166 offset:4096
    ds_read_b64_tr_b16 v[36:37], v176 offset:12288
    ds_read_b64_tr_b16 v[38:39], v176 offset:12800
    v_mfma_f32_32x32x16_bf16 v[96:111], v[24:27], v[48:51], v[96:111]
    ds_read_b64_tr_b16 v[40:41], v176 offset:20480
    ds_read_b64_tr_b16 v[42:43], v176 offset:20992
    v_mfma_f32_32x32x16_bf16 v[112:127], v[28:31], v[48:51], v[112:127]
    v_mfma_f32_32x32x16_bf16 v[128:143], v[24:27], v[52:55], v[128:143]
    v_mfma_f32_32x32x16_bf16 v[144:159], v[28:31], v[52:55], v[144:159]
    s_waitcnt lgkmcnt(0)
    v_mfma_f32_32x32x16_bf16 v[64:79], v[32:35], v[16:19], v[64:79]
    ds_read_b64_tr_b16 v[44:45], v176 offset:6144
    ds_read_b64_tr_b16 v[46:47], v176 offset:6656
    ds_read_b128 v[24:27], v167 offset:0
    v_mfma_f32_32x32x16_bf16 v[80:95], v[32:35], v[20:23], v[80:95]
    ds_read_b128 v[28:31], v167 offset:4096
    ds_read_b64_tr_b16 v[48:49], v176 offset:14336
    ds_read_b64_tr_b16 v[50:51], v176 offset:14848
    v_mfma_f32_32x32x16_bf16 v[96:111], v[16:19], v[36:39], v[96:111]
    ds_read_b64_tr_b16 v[52:53], v176 offset:22528
    ds_read_b64_tr_b16 v[54:55], v176 offset:23040
    v_mfma_f32_32x32x16_bf16 v[112:127], v[20:23], v[36:39], v[112:127]
    v_mfma_f32_32x32x16_bf16 v[128:143], v[16:19], v[40:43], v[128:143]
    v_mfma_f32_32x32x16_bf16 v[144:159], v[20:23], v[40:43], v[144:159]
    s_waitcnt lgkmcnt(0)
    v_mfma_f32_32x32x16_bf16 v[64:79], v[44:47], v[24:27], v[64:79]
    v_mfma_f32_32x32x16_bf16 v[80:95], v[44:47], v[28:31], v[80:95]
    v_mfma_f32_32x32x16_bf16 v[96:111], v[24:27], v[48:51], v[96:111]
    v_mfma_f32_32x32x16_bf16 v[112:127], v[28:31], v[48:51], v[112:127]
    v_mfma_f32_32x32x16_bf16 v[128:143], v[24:27], v[52:55], v[128:143]
    v_mfma_f32_32x32x16_bf16 v[144:159], v[28:31], v[52:55], v[144:159]
    s_lshl_b32 s42, s26, 1
    s_add_u32 s42, s42, s41
    v_lshlrev_b32 v12, 4, v1
    v_mov_b32 v160, 0x3f803f80
    v_mov_b32 v161, 0x3f803f80
    v_mov_b32 v162, 0x3f803f80
    v_mov_b32 v163, 0x3f803f80
    s_nop 1
    v_cvt_pk_bf16_f32 v48, v96, v97
    v_cvt_pk_bf16_f32 v49, v98, v99
    v_cvt_pk_bf16_f32 v50, v100, v101
    v_cvt_pk_bf16_f32 v51, v102, v103
    v_cvt_pk_bf16_f32 v52, v104, v105
    v_cvt_pk_bf16_f32 v53, v106, v107
    v_cvt_pk_bf16_f32 v54, v108, v109
    v_cvt_pk_bf16_f32 v55, v110, v111
    v_lshlrev_b32 v16, 16, v48
    v_and_b32 v17, 0xffff0000, v48
    v_lshlrev_b32 v18, 16, v49
    v_and_b32 v19, 0xffff0000, v49
    v_lshlrev_b32 v20, 16, v50
    v_and_b32 v21, 0xffff0000, v50
    v_lshlrev_b32 v22, 16, v51
    v_and_b32 v23, 0xffff0000, v51
    v_lshlrev_b32 v24, 16, v52
    v_and_b32 v25, 0xffff0000, v52
    v_lshlrev_b32 v26, 16, v53
    v_and_b32 v27, 0xffff0000, v53
    v_lshlrev_b32 v28, 16, v54
    v_and_b32 v29, 0xffff0000, v54
    v_lshlrev_b32 v30, 16, v55
    v_and_b32 v31, 0xffff0000, v55
    v_pk_mul_f32 v[32:33], v[16:17], s[60:61]
    v_pk_mul_f32 v[34:35], v[18:19], s[60:61]
    v_pk_mul_f32 v[36:37], v[20:21], s[60:61]
    v_pk_mul_f32 v[38:39], v[22:23], s[60:61]
    v_pk_mul_f32 v[40:41], v[24:25], s[60:61]
    v_pk_mul_f32 v[42:43], v[26:27], s[60:61]
    v_pk_mul_f32 v[44:45], v[28:29], s[60:61]
    v_pk_mul_f32 v[46:47], v[30:31], s[60:61]
    v_min_f32 v32, 0, v32
    v_min_f32 v33, 0, v33
    v_min_f32 v34, 0, v34
    v_min_f32 v35, 0, v35
    v_min_f32 v36, 0, v36
    v_min_f32 v37, 0, v37
    v_min_f32 v38, 0, v38
    v_min_f32 v39, 0, v39
    v_min_f32 v40, 0, v40
    v_min_f32 v41, 0, v41
    v_min_f32 v42, 0, v42
    v_min_f32 v43, 0, v43
    v_min_f32 v44, 0, v44
    v_min_f32 v45, 0, v45
    v_min_f32 v46, 0, v46
    v_min_f32 v47, 0, v47
    v_exp_f32 v32, v32
    v_max_f32 v16, 0, v16
    v_exp_f32 v33, v33
    v_max_f32 v17, 0, v17
    v_exp_f32 v34, v34
    v_max_f32 v18, 0, v18
    v_exp_f32 v35, v35
    v_max_f32 v19, 0, v19
    v_exp_f32 v36, v36
    v_max_f32 v20, 0, v20
    v_exp_f32 v37, v37
    v_max_f32 v21, 0, v21
    v_exp_f32 v38, v38
    v_max_f32 v22, 0, v22
    v_exp_f32 v39, v39
    v_max_f32 v23, 0, v23
    v_exp_f32 v40, v40
    v_max_f32 v24, 0, v24
    v_exp_f32 v41, v41
    v_max_f32 v25, 0, v25
    v_exp_f32 v42, v42
    v_max_f32 v26, 0, v26
    v_exp_f32 v43, v43
    v_max_f32 v27, 0, v27
    v_exp_f32 v44, v44
    v_max_f32 v28, 0, v28
    v_exp_f32 v45, v45
    v_max_f32 v29, 0, v29
    v_exp_f32 v46, v46
    v_max_f32 v30, 0, v30
    v_exp_f32 v47, v47
    v_max_f32 v31, 0, v31
    v_pk_add_f32 v[32:33], v[32:33], v[16:17]
    v_pk_add_f32 v[34:35], v[34:35], v[18:19]
    v_pk_add_f32 v[36:37], v[36:37], v[20:21]
    v_pk_add_f32 v[38:39], v[38:39], v[22:23]
    v_pk_add_f32 v[40:41], v[40:41], v[24:25]
    v_pk_add_f32 v[42:43], v[42:43], v[26:27]
    v_pk_add_f32 v[44:45], v[44:45], v[28:29]
    v_pk_add_f32 v[46:47], v[46:47], v[30:31]
    v_cvt_pk_bf16_f32 v48, v32, v33
    v_cvt_pk_bf16_f32 v49, v34, v35
    v_cvt_pk_bf16_f32 v50, v36, v37
    v_cvt_pk_bf16_f32 v51, v38, v39
    v_cvt_pk_bf16_f32 v52, v40, v41
    v_cvt_pk_bf16_f32 v53, v42, v43
    v_cvt_pk_bf16_f32 v54, v44, v45
    v_cvt_pk_bf16_f32 v55, v46, v47
    v_lshlrev_b32 v32, 16, v48
    v_and_b32 v33, 0xffff0000, v48
    v_lshlrev_b32 v34, 16, v49
    v_and_b32 v35, 0xffff0000, v49
    v_lshlrev_b32 v36, 16, v50
    v_and_b32 v37, 0xffff0000, v50
    v_lshlrev_b32 v38, 16, v51
    v_and_b32 v39, 0xffff0000, v51
    v_lshlrev_b32 v40, 16, v52
    v_and_b32 v41, 0xffff0000, v52
    v_lshlrev_b32 v42, 16, v53
    v_and_b32 v43, 0xffff0000, v53
    v_lshlrev_b32 v44, 16, v54
    v_and_b32 v45, 0xffff0000, v54
    v_lshlrev_b32 v46, 16, v55
    v_and_b32 v47, 0xffff0000, v55
    v_pk_add_f32 v[16:17], v[32:33], s[62:63]
    v_pk_add_f32 v[18:19], v[34:35], s[62:63]
    v_pk_add_f32 v[20:21], v[36:37], s[62:63]
    v_pk_add_f32 v[22:23], v[38:39], s[62:63]
    v_pk_add_f32 v[24:25], v[40:41], s[62:63]
    v_pk_add_f32 v[26:27], v[42:43], s[62:63]
    v_pk_add_f32 v[28:29], v[44:45], s[62:63]
    v_pk_add_f32 v[30:31], v[46:47], s[62:63]
    v_cvt_pk_bf16_f32 v96, v16, v17
    v_cvt_pk_bf16_f32 v97, v18, v19
    v_cvt_pk_bf16_f32 v98, v20, v21
    v_cvt_pk_bf16_f32 v99, v22, v23
    v_cvt_pk_bf16_f32 v100, v24, v25
    v_cvt_pk_bf16_f32 v101, v26, v27
    v_cvt_pk_bf16_f32 v102, v28, v29
    v_cvt_pk_bf16_f32 v103, v30, v31
    v_cvt_pk_bf16_f32 v128, v128, v129
    v_cvt_pk_bf16_f32 v129, v130, v131
    v_cvt_pk_bf16_f32 v130, v132, v133
    v_cvt_pk_bf16_f32 v131, v134, v135
    v_cvt_pk_bf16_f32 v132, v136, v137
    v_cvt_pk_bf16_f32 v133, v138, v139
    v_cvt_pk_bf16_f32 v134, v140, v141
    v_cvt_pk_bf16_f32 v135, v142, v143
    v_mfma_f32_32x32x16_bf16 v[192:207], v[96:99], v[128:131], 0
    v_mfma_f32_32x32x16_bf16 v[208:223], v[96:99], v[160:163], 0
    v_mfma_f32_32x32x16_bf16 v[192:207], v[100:103], v[132:135], v[192:207]
    v_mfma_f32_32x32x16_bf16 v[208:223], v[100:103], v[160:163], v[208:223]
    v_cvt_pk_bf16_f32 v48, v112, v113
    v_cvt_pk_bf16_f32 v49, v114, v115
    v_cvt_pk_bf16_f32 v50, v116, v117
    v_cvt_pk_bf16_f32 v51, v118, v119
    v_cvt_pk_bf16_f32 v52, v120, v121
    v_cvt_pk_bf16_f32 v53, v122, v123
    v_cvt_pk_bf16_f32 v54, v124, v125
    v_cvt_pk_bf16_f32 v55, v126, v127
    v_lshlrev_b32 v16, 16, v48
    v_and_b32 v17, 0xffff0000, v48
    v_lshlrev_b32 v18, 16, v49
    v_and_b32 v19, 0xffff0000, v49
    v_lshlrev_b32 v20, 16, v50
    v_and_b32 v21, 0xffff0000, v50
    v_lshlrev_b32 v22, 16, v51
    v_and_b32 v23, 0xffff0000, v51
    v_lshlrev_b32 v24, 16, v52
    v_and_b32 v25, 0xffff0000, v52
    v_lshlrev_b32 v26, 16, v53
    v_and_b32 v27, 0xffff0000, v53
    v_lshlrev_b32 v28, 16, v54
    v_and_b32 v29, 0xffff0000, v54
    v_lshlrev_b32 v30, 16, v55
    v_and_b32 v31, 0xffff0000, v55
    v_pk_mul_f32 v[32:33], v[16:17], s[60:61]
    v_pk_mul_f32 v[34:35], v[18:19], s[60:61]
    v_pk_mul_f32 v[36:37], v[20:21], s[60:61]
    v_pk_mul_f32 v[38:39], v[22:23], s[60:61]
    v_pk_mul_f32 v[40:41], v[24:25], s[60:61]
    v_pk_mul_f32 v[42:43], v[26:27], s[60:61]
    v_pk_mul_f32 v[44:45], v[28:29], s[60:61]
    v_pk_mul_f32 v[46:47], v[30:31], s[60:61]
    v_min_f32 v32, 0, v32
    v_min_f32 v33, 0, v33
    v_min_f32 v34, 0, v34
    v_min_f32 v35, 0, v35
    v_min_f32 v36, 0, v36
    v_min_f32 v37, 0, v37
    v_min_f32 v38, 0, v38
    v_min_f32 v39, 0, v39
    v_min_f32 v40, 0, v40
    v_min_f32 v41, 0, v41
    v_min_f32 v42, 0, v42
    v_min_f32 v43, 0, v43
    v_min_f32 v44, 0, v44
    v_min_f32 v45, 0, v45
    v_min_f32 v46, 0, v46
    v_min_f32 v47, 0, v47
    v_exp_f32 v32, v32
    v_max_f32 v16, 0, v16
    v_exp_f32 v33, v33
    v_max_f32 v17, 0, v17
    v_exp_f32 v34, v34
    v_max_f32 v18, 0, v18
    v_exp_f32 v35, v35
    v_max_f32 v19, 0, v19
    v_exp_f32 v36, v36
    v_max_f32 v20, 0, v20
    v_exp_f32 v37, v37
    v_max_f32 v21, 0, v21
    v_exp_f32 v38, v38
    v_max_f32 v22, 0, v22
    v_exp_f32 v39, v39
    v_max_f32 v23, 0, v23
    v_exp_f32 v40, v40
    v_max_f32 v24, 0, v24
    v_exp_f32 v41, v41
    v_max_f32 v25, 0, v25
    v_exp_f32 v42, v42
    v_max_f32 v26, 0, v26
    v_exp_f32 v43, v43
    v_max_f32 v27, 0, v27
    v_exp_f32 v44, v44
    v_max_f32 v28, 0, v28
    v_exp_f32 v45, v45
    v_max_f32 v29, 0, v29
    v_exp_f32 v46, v46
    v_max_f32 v30, 0, v30
    v_exp_f32 v47, v47
    v_max_f32 v31, 0, v31
    v_pk_add_f32 v[32:33], v[32:33], v[16:17]
    v_pk_add_f32 v[34:35], v[34:35], v[18:19]
    v_pk_add_f32 v[36:37], v[36:37], v[20:21]
    v_pk_add_f32 v[38:39], v[38:39], v[22:23]
    v_pk_add_f32 v[40:41], v[40:41], v[24:25]
    v_pk_add_f32 v[42:43], v[42:43], v[26:27]
    v_pk_add_f32 v[44:45], v[44:45], v[28:29]
    v_pk_add_f32 v[46:47], v[46:47], v[30:31]
    v_cvt_pk_bf16_f32 v48, v32, v33
    v_cvt_pk_bf16_f32 v49, v34, v35
    v_cvt_pk_bf16_f32 v50, v36, v37
    v_cvt_pk_bf16_f32 v51, v38, v39
    v_cvt_pk_bf16_f32 v52, v40, v41
    v_cvt_pk_bf16_f32 v53, v42, v43
    v_cvt_pk_bf16_f32 v54, v44, v45
    v_cvt_pk_bf16_f32 v55, v46, v47
    v_lshlrev_b32 v32, 16, v48
    v_and_b32 v33, 0xffff0000, v48
    v_lshlrev_b32 v34, 16, v49
    v_and_b32 v35, 0xffff0000, v49
    v_lshlrev_b32 v36, 16, v50
    v_and_b32 v37, 0xffff0000, v50
    v_lshlrev_b32 v38, 16, v51
    v_and_b32 v39, 0xffff0000, v51
    v_lshlrev_b32 v40, 16, v52
    v_and_b32 v41, 0xffff0000, v52
    v_lshlrev_b32 v42, 16, v53
    v_and_b32 v43, 0xffff0000, v53
    v_lshlrev_b32 v44, 16, v54
    v_and_b32 v45, 0xffff0000, v54
    v_lshlrev_b32 v46, 16, v55
    v_and_b32 v47, 0xffff0000, v55
    v_pk_add_f32 v[16:17], v[32:33], s[62:63]
    v_pk_add_f32 v[18:19], v[34:35], s[62:63]
    v_pk_add_f32 v[20:21], v[36:37], s[62:63]
    v_pk_add_f32 v[22:23], v[38:39], s[62:63]
    v_pk_add_f32 v[24:25], v[40:41], s[62:63]
    v_pk_add_f32 v[26:27], v[42:43], s[62:63]
    v_pk_add_f32 v[28:29], v[44:45], s[62:63]
    v_pk_add_f32 v[30:31], v[46:47], s[62:63]
    v_cvt_pk_bf16_f32 v112, v16, v17
    v_cvt_pk_bf16_f32 v113, v18, v19
    v_cvt_pk_bf16_f32 v114, v20, v21
    v_cvt_pk_bf16_f32 v115, v22, v23
    v_cvt_pk_bf16_f32 v116, v24, v25
    v_cvt_pk_bf16_f32 v117, v26, v27
    v_cvt_pk_bf16_f32 v118, v28, v29
    v_cvt_pk_bf16_f32 v119, v30, v31
    v_cvt_pk_bf16_f32 v144, v144, v145
    v_cvt_pk_bf16_f32 v145, v146, v147
    v_cvt_pk_bf16_f32 v146, v148, v149
    v_cvt_pk_bf16_f32 v147, v150, v151
    v_cvt_pk_bf16_f32 v148, v152, v153
    v_cvt_pk_bf16_f32 v149, v154, v155
    v_cvt_pk_bf16_f32 v150, v156, v157
    v_cvt_pk_bf16_f32 v151, v158, v159
    v_mfma_f32_32x32x16_bf16 v[192:207], v[112:115], v[144:147], v[192:207]
    v_mfma_f32_32x32x16_bf16 v[208:223], v[112:115], v[160:163], v[208:223]
    v_mfma_f32_32x32x16_bf16 v[192:207], v[116:119], v[148:151], v[192:207]
    v_mfma_f32_32x32x16_bf16 v[208:223], v[116:119], v[160:163], v[208:223]
    s_barrier
    s_lshl_b32 s32, s24, 13
    v_add_u32 v13, s32, v12
    s_cmp_eq_u32 s40, 0
    s_cbranch_scc1 L_mh0_1
    s_nop 5
    ds_write_b128 v13, v[192:195] offset:0
    ds_write_b128 v13, v[196:199] offset:1024
    ds_write_b128 v13, v[200:203] offset:2048
    ds_write_b128 v13, v[204:207] offset:3072
    ds_write_b128 v13, v[208:211] offset:4096
    ds_write_b128 v13, v[212:215] offset:5120
    ds_write_b128 v13, v[216:219] offset:6144
    ds_write_b128 v13, v[220:223] offset:7168
    s_waitcnt lgkmcnt(0)
    s_barrier
    s_branch L_join_2
    s_nop 0
L_mh0_1:
    s_barrier
    ds_read_b128 v[96:99], v13 offset:16384
    ds_read_b128 v[100:103], v13 offset:17408
    ds_read_b128 v[104:107], v13 offset:18432
    ds_read_b128 v[108:111], v13 offset:19456
    ds_read_b128 v[112:115], v13 offset:20480
    ds_read_b128 v[116:119], v13 offset:21504
    ds_read_b128 v[120:123], v13 offset:22528
    ds_read_b128 v[124:127], v13 offset:23552
    s_waitcnt lgkmcnt(0)
    v_add_f32 v192, v96, v192
    v_add_f32 v193, v97, v193
    v_add_f32 v194, v98, v194
    v_add_f32 v195, v99, v195
    v_add_f32 v196, v100, v196
    v_add_f32 v197, v101, v197
    v_add_f32 v198, v102, v198
    v_add_f32 v199, v103, v199
    v_add_f32 v200, v104, v200
    v_add_f32 v201, v105, v201
    v_add_f32 v202, v106, v202
    v_add_f32 v203, v107, v203
    v_add_f32 v204, v108, v204
    v_add_f32 v205, v109, v205
    v_add_f32 v206, v110, v206
    v_add_f32 v207, v111, v207
    v_add_f32 v208, v112, v208
    v_add_f32 v209, v113, v209
    v_add_f32 v210, v114, v210
    v_add_f32 v211, v115, v211
    v_add_f32 v212, v116, v212
    v_add_f32 v213, v117, v213
    v_add_f32 v214, v118, v214
    v_add_f32 v215, v119, v215
    v_add_f32 v216, v120, v216
    v_add_f32 v217, v121, v217
    v_add_f32 v218, v122, v218
    v_add_f32 v219, v123, v219
    v_add_f32 v220, v124, v220
    v_add_f32 v221, v125, v221
    v_add_f32 v222, v126, v222
    v_add_f32 v223, v127, v223
    ds_read_b128 v[96:99], v13 offset:32768
    ds_read_b128 v[100:103], v13 offset:33792
    ds_read_b128 v[104:107], v13 offset:34816
    ds_read_b128 v[108:111], v13 offset:35840
    ds_read_b128 v[112:115], v13 offset:36864
    ds_read_b128 v[116:119], v13 offset:37888
    ds_read_b128 v[120:123], v13 offset:38912
    ds_read_b128 v[124:127], v13 offset:39936
    s_waitcnt lgkmcnt(0)
    v_add_f32 v192, v96, v192
    v_add_f32 v193, v97, v193
    v_add_f32 v194, v98, v194
    v_add_f32 v195, v99, v195
    v_add_f32 v196, v100, v196
    v_add_f32 v197, v101, v197
    v_add_f32 v198, v102, v198
    v_add_f32 v199, v103, v199
    v_add_f32 v200, v104, v200
    v_add_f32 v201, v105, v201
    v_add_f32 v202, v106, v202
    v_add_f32 v203, v107, v203
    v_add_f32 v204, v108, v204
    v_add_f32 v205, v109, v205
    v_add_f32 v206, v110, v206
    v_add_f32 v207, v111, v207
    v_add_f32 v208, v112, v208
    v_add_f32 v209, v113, v209
    v_add_f32 v210, v114, v210
    v_add_f32 v211, v115, v211
    v_add_f32 v212, v116, v212
    v_add_f32 v213, v117, v213
    v_add_f32 v214, v118, v214
    v_add_f32 v215, v119, v215
    v_add_f32 v216, v120, v216
    v_add_f32 v217, v121, v217
    v_add_f32 v218, v122, v218
    v_add_f32 v219, v123, v219
    v_add_f32 v220, v124, v220
    v_add_f32 v221, v125, v221
    v_add_f32 v222, v126, v222
    v_add_f32 v223, v127, v223
    ds_read_b128 v[96:99], v13 offset:49152
    ds_read_b128 v[100:103], v13 offset:50176
    ds_read_b128 v[104:107], v13 offset:51200
    ds_read_b128 v[108:111], v13 offset:52224
    ds_read_b128 v[112:115], v13 offset:53248
    ds_read_b128 v[116:119], v13 offset:54272
    ds_read_b128 v[120:123], v13 offset:55296
    ds_read_b128 v[124:127], v13 offset:56320
    s_waitcnt lgkmcnt(0)
    v_add_f32 v192, v96, v192
    v_add_f32 v193, v97, v193
    v_add_f32 v194, v98, v194
    v_add_f32 v195, v99, v195
    v_add_f32 v196, v100, v196
    v_add_f32 v197, v101, v197
    v_add_f32 v198, v102, v198
    v_add_f32 v199, v103, v199
    v_add_f32 v200, v104, v200
    v_add_f32 v201, v105, v201
    v_add_f32 v202, v106, v202
    v_add_f32 v203, v107, v203
    v_add_f32 v204, v108, v204
    v_add_f32 v205, v109, v205
    v_add_f32 v206, v110, v206
    v_add_f32 v207, v111, v207
    v_add_f32 v208, v112, v208
    v_add_f32 v209, v113, v209
    v_add_f32 v210, v114, v210
    v_add_f32 v211, v115, v211
    v_add_f32 v212, v116, v212
    v_add_f32 v213, v117, v213
    v_add_f32 v214, v118, v214
    v_add_f32 v215, v119, v215
    v_add_f32 v216, v120, v216
    v_add_f32 v217, v121, v217
    v_add_f32 v218, v122, v218
    v_add_f32 v219, v123, v219
    v_add_f32 v220, v124, v220
    v_add_f32 v221, v125, v221
    v_add_f32 v222, v126, v222
    v_add_f32 v223, v127, v223
    s_lshl_b32 s33, s42, 3
    s_add_u32 s33, s33, s25
    s_mul_i32 s33, s33, 4608
    s_add_u32 s33, s33, 4194304
    buffer_store_dwordx4 v[192:195], v12, s[16:19], s33 offen offset:0 sc1
    buffer_store_dwordx4 v[196:199], v12, s[16:19], s33 offen offset:1024 sc1
    buffer_store_dwordx4 v[200:203], v12, s[16:19], s33 offen offset:2048 sc1
    buffer_store_dwordx4 v[204:207], v12, s[16:19], s33 offen offset:3072 sc1
    v_lshrrev_b32 v14, 5, v1
    v_lshlrev_b32 v14, 4, v14
    s_add_u32 s33, s33, 4096
    s_mov_b32 exec_lo, 1
    s_mov_b32 exec_hi, 1
    buffer_store_dwordx4 v[208:211], v14, s[16:19], s33 offen offset:0 sc1
    buffer_store_dwordx4 v[212:215], v14, s[16:19], s33 offen offset:32 sc1
    buffer_store_dwordx4 v[216:219], v14, s[16:19], s33 offen offset:64 sc1
    buffer_store_dwordx4 v[220:223], v14, s[16:19], s33 offen offset:96 sc1
    s_mov_b64 exec, -1
    s_nop 0
L_join_2:
    v_cvt_pk_bf16_f32 v48, v64, v65
    v_cvt_pk_bf16_f32 v49, v66, v67
    v_cvt_pk_bf16_f32 v50, v68, v69
    v_cvt_pk_bf16_f32 v51, v70, v71
    v_cvt_pk_bf16_f32 v52, v72, v73
    v_cvt_pk_bf16_f32 v53, v74, v75
    v_cvt_pk_bf16_f32 v54, v76, v77
    v_cvt_pk_bf16_f32 v55, v78, v79
    v_lshlrev_b32 v16, 16, v48
    v_and_b32 v17, 0xffff0000, v48
    v_lshlrev_b32 v18, 16, v49
    v_and_b32 v19, 0xffff0000, v49
    v_lshlrev_b32 v20, 16, v50
    v_and_b32 v21, 0xffff0000, v50
    v_lshlrev_b32 v22, 16, v51
    v_and_b32 v23, 0xffff0000, v51
    v_lshlrev_b32 v24, 16, v52
    v_and_b32 v25, 0xffff0000, v52
    v_lshlrev_b32 v26, 16, v53
    v_and_b32 v27, 0xffff0000, v53
    v_lshlrev_b32 v28, 16, v54
    v_and_b32 v29, 0xffff0000, v54
    v_lshlrev_b32 v30, 16, v55
    v_and_b32 v31, 0xffff0000, v55
    v_pk_mul_f32 v[32:33], v[16:17], s[60:61]
    v_pk_mul_f32 v[34:35], v[18:19], s[60:61]
    v_pk_mul_f32 v[36:37], v[20:21], s[60:61]
    v_pk_mul_f32 v[38:39], v[22:23], s[60:61]
    v_pk_mul_f32 v[40:41], v[24:25], s[60:61]
    v_pk_mul_f32 v[42:43], v[26:27], s[60:61]
    v_pk_mul_f32 v[44:45], v[28:29], s[60:61]
    v_pk_mul_f32 v[46:47], v[30:31], s[60:61]
    v_min_f32 v32, 0, v32
    v_min_f32 v33, 0, v33
    v_min_f32 v34, 0, v34
    v_min_f32 v35, 0, v35
    v_min_f32 v36, 0, v36
    v_min_f32 v37, 0, v37
    v_min_f32 v38, 0, v38
    v_min_f32 v39, 0, v39
    v_min_f32 v40, 0, v40
    v_min_f32 v41, 0, v41
    v_min_f32 v42, 0, v42
    v_min_f32 v43, 0, v43
    v_min_f32 v44, 0, v44
    v_min_f32 v45, 0, v45
    v_min_f32 v46, 0, v46
    v_min_f32 v47, 0, v47
    v_exp_f32 v32, v32
    v_max_f32 v16, 0, v16
    v_exp_f32 v33, v33
    v_max_f32 v17, 0, v17
    v_exp_f32 v34, v34
    v_max_f32 v18, 0, v18
    v_exp_f32 v35, v35
    v_max_f32 v19, 0, v19
    v_exp_f32 v36, v36
    v_max_f32 v20, 0, v20
    v_exp_f32 v37, v37
    v_max_f32 v21, 0, v21
    v_exp_f32 v38, v38
    v_max_f32 v22, 0, v22
    v_exp_f32 v39, v39
    v_max_f32 v23, 0, v23
    v_exp_f32 v40, v40
    v_max_f32 v24, 0, v24
    v_exp_f32 v41, v41
    v_max_f32 v25, 0, v25
    v_exp_f32 v42, v42
    v_max_f32 v26, 0, v26
    v_exp_f32 v43, v43
    v_max_f32 v27, 0, v27
    v_exp_f32 v44, v44
    v_max_f32 v28, 0, v28
    v_exp_f32 v45, v45
    v_max_f32 v29, 0, v29
    v_exp_f32 v46, v46
    v_max_f32 v30, 0, v30
    v_exp_f32 v47, v47
    v_max_f32 v31, 0, v31
    v_pk_add_f32 v[32:33], v[32:33], v[16:17]
    v_pk_add_f32 v[34:35], v[34:35], v[18:19]
    v_pk_add_f32 v[36:37], v[36:37], v[20:21]
    v_pk_add_f32 v[38:39], v[38:39], v[22:23]
    v_pk_add_f32 v[40:41], v[40:41], v[24:25]
    v_pk_add_f32 v[42:43], v[42:43], v[26:27]
    v_pk_add_f32 v[44:45], v[44:45], v[28:29]
    v_pk_add_f32 v[46:47], v[46:47], v[30:31]
    v_cvt_pk_bf16_f32 v48, v32, v33
    v_cvt_pk_bf16_f32 v49, v34, v35
    v_cvt_pk_bf16_f32 v50, v36, v37
    v_cvt_pk_bf16_f32 v51, v38, v39
    v_cvt_pk_bf16_f32 v52, v40, v41
    v_cvt_pk_bf16_f32 v53, v42, v43
    v_cvt_pk_bf16_f32 v54, v44, v45
    v_cvt_pk_bf16_f32 v55, v46, v47
    v_lshlrev_b32 v32, 16, v48
    v_and_b32 v33, 0xffff0000, v48
    v_lshlrev_b32 v34, 16, v49
    v_and_b32 v35, 0xffff0000, v49
    v_lshlrev_b32 v36, 16, v50
    v_and_b32 v37, 0xffff0000, v50
    v_lshlrev_b32 v38, 16, v51
    v_and_b32 v39, 0xffff0000, v51
    v_lshlrev_b32 v40, 16, v52
    v_and_b32 v41, 0xffff0000, v52
    v_lshlrev_b32 v42, 16, v53
    v_and_b32 v43, 0xffff0000, v53
    v_lshlrev_b32 v44, 16, v54
    v_and_b32 v45, 0xffff0000, v54
    v_lshlrev_b32 v46, 16, v55
    v_and_b32 v47, 0xffff0000, v55
    v_pk_add_f32 v[16:17], v[32:33], s[62:63]
    v_pk_add_f32 v[18:19], v[34:35], s[62:63]
    v_pk_add_f32 v[20:21], v[36:37], s[62:63]
    v_pk_add_f32 v[22:23], v[38:39], s[62:63]
    v_pk_add_f32 v[24:25], v[40:41], s[62:63]
    v_pk_add_f32 v[26:27], v[42:43], s[62:63]
    v_pk_add_f32 v[28:29], v[44:45], s[62:63]
    v_pk_add_f32 v[30:31], v[46:47], s[62:63]
    v_cvt_pk_bf16_f32 v64, v16, v17
    v_cvt_pk_bf16_f32 v65, v18, v19
    v_cvt_pk_bf16_f32 v66, v20, v21
    v_cvt_pk_bf16_f32 v67, v22, v23
    v_cvt_pk_bf16_f32 v68, v24, v25
    v_cvt_pk_bf16_f32 v69, v26, v27
    v_cvt_pk_bf16_f32 v70, v28, v29
    v_cvt_pk_bf16_f32 v71, v30, v31
    s_waitcnt vmcnt(0)
    s_barrier
    s_cmp_lg_u32 s24, 0
    s_cbranch_scc1 L_noat_3
    s_mov_b64 exec, 1
    v_mov_b32 v14, 1
    s_lshl_b32 s32, s26, 2
    v_mov_b32 v15, s32
    buffer_atomic_add v14, v15, s[20:23], 0 offen sc0 sc1
    s_mov_b64 exec, -1
    s_nop 0
L_noat_3:
    s_lshl_b32 s32, s25, 3
    s_lshl_b32 s33, s40, 1
    s_add_u32 s32, s32, s33
    s_lshl_b32 s32, s32, 5
    s_add_u32 s32, s32, s42
    s_lshl_b32 s32, s32, 11
    buffer_store_dwordx4 v[64:67], v12, s[16:19], s32 offen sc1
    buffer_store_dwordx4 v[68:71], v12, s[16:19], s32 offen offset:1024 sc1
    v_cvt_pk_bf16_f32 v48, v80, v81
    v_cvt_pk_bf16_f32 v49, v82, v83
    v_cvt_pk_bf16_f32 v50, v84, v85
    v_cvt_pk_bf16_f32 v51, v86, v87
    v_cvt_pk_bf16_f32 v52, v88, v89
    v_cvt_pk_bf16_f32 v53, v90, v91
    v_cvt_pk_bf16_f32 v54, v92, v93
    v_cvt_pk_bf16_f32 v55, v94, v95
    v_lshlrev_b32 v16, 16, v48
    v_and_b32 v17, 0xffff0000, v48
    v_lshlrev_b32 v18, 16, v49
    v_and_b32 v19, 0xffff0000, v49
    v_lshlrev_b32 v20, 16, v50
    v_and_b32 v21, 0xffff0000, v50
    v_lshlrev_b32 v22, 16, v51
    v_and_b32 v23, 0xffff0000, v51
    v_lshlrev_b32 v24, 16, v52
    v_and_b32 v25, 0xffff0000, v52
    v_lshlrev_b32 v26, 16, v53
    v_and_b32 v27, 0xffff0000, v53
    v_lshlrev_b32 v28, 16, v54
    v_and_b32 v29, 0xffff0000, v54
    v_lshlrev_b32 v30, 16, v55
    v_and_b32 v31, 0xffff0000, v55
    v_pk_mul_f32 v[32:33], v[16:17], s[60:61]
    v_pk_mul_f32 v[34:35], v[18:19], s[60:61]
    v_pk_mul_f32 v[36:37], v[20:21], s[60:61]
    v_pk_mul_f32 v[38:39], v[22:23], s[60:61]
    v_pk_mul_f32 v[40:41], v[24:25], s[60:61]
    v_pk_mul_f32 v[42:43], v[26:27], s[60:61]
    v_pk_mul_f32 v[44:45], v[28:29], s[60:61]
    v_pk_mul_f32 v[46:47], v[30:31], s[60:61]
    v_min_f32 v32, 0, v32
    v_min_f32 v33, 0, v33
    v_min_f32 v34, 0, v34
    v_min_f32 v35, 0, v35
    v_min_f32 v36, 0, v36
    v_min_f32 v37, 0, v37
    v_min_f32 v38, 0, v38
    v_min_f32 v39, 0, v39
    v_min_f32 v40, 0, v40
    v_min_f32 v41, 0, v41
    v_min_f32 v42, 0, v42
    v_min_f32 v43, 0, v43
    v_min_f32 v44, 0, v44
    v_min_f32 v45, 0, v45
    v_min_f32 v46, 0, v46
    v_min_f32 v47, 0, v47
    v_exp_f32 v32, v32
    v_max_f32 v16, 0, v16
    v_exp_f32 v33, v33
    v_max_f32 v17, 0, v17
    v_exp_f32 v34, v34
    v_max_f32 v18, 0, v18
    v_exp_f32 v35, v35
    v_max_f32 v19, 0, v19
    v_exp_f32 v36, v36
    v_max_f32 v20, 0, v20
    v_exp_f32 v37, v37
    v_max_f32 v21, 0, v21
    v_exp_f32 v38, v38
    v_max_f32 v22, 0, v22
    v_exp_f32 v39, v39
    v_max_f32 v23, 0, v23
    v_exp_f32 v40, v40
    v_max_f32 v24, 0, v24
    v_exp_f32 v41, v41
    v_max_f32 v25, 0, v25
    v_exp_f32 v42, v42
    v_max_f32 v26, 0, v26
    v_exp_f32 v43, v43
    v_max_f32 v27, 0, v27
    v_exp_f32 v44, v44
    v_max_f32 v28, 0, v28
    v_exp_f32 v45, v45
    v_max_f32 v29, 0, v29
    v_exp_f32 v46, v46
    v_max_f32 v30, 0, v30
    v_exp_f32 v47, v47
    v_max_f32 v31, 0, v31
    v_pk_add_f32 v[32:33], v[32:33], v[16:17]
    v_pk_add_f32 v[34:35], v[34:35], v[18:19]
    v_pk_add_f32 v[36:37], v[36:37], v[20:21]
    v_pk_add_f32 v[38:39], v[38:39], v[22:23]
    v_pk_add_f32 v[40:41], v[40:41], v[24:25]
    v_pk_add_f32 v[42:43], v[42:43], v[26:27]
    v_pk_add_f32 v[44:45], v[44:45], v[28:29]
    v_pk_add_f32 v[46:47], v[46:47], v[30:31]
    v_cvt_pk_bf16_f32 v48, v32, v33
    v_cvt_pk_bf16_f32 v49, v34, v35
    v_cvt_pk_bf16_f32 v50, v36, v37
    v_cvt_pk_bf16_f32 v51, v38, v39
    v_cvt_pk_bf16_f32 v52, v40, v41
    v_cvt_pk_bf16_f32 v53, v42, v43
    v_cvt_pk_bf16_f32 v54, v44, v45
    v_cvt_pk_bf16_f32 v55, v46, v47
    v_lshlrev_b32 v32, 16, v48
    v_and_b32 v33, 0xffff0000, v48
    v_lshlrev_b32 v34, 16, v49
    v_and_b32 v35, 0xffff0000, v49
    v_lshlrev_b32 v36, 16, v50
    v_and_b32 v37, 0xffff0000, v50
    v_lshlrev_b32 v38, 16, v51
    v_and_b32 v39, 0xffff0000, v51
    v_lshlrev_b32 v40, 16, v52
    v_and_b32 v41, 0xffff0000, v52
    v_lshlrev_b32 v42, 16, v53
    v_and_b32 v43, 0xffff0000, v53
    v_lshlrev_b32 v44, 16, v54
    v_and_b32 v45, 0xffff0000, v54
    v_lshlrev_b32 v46, 16, v55
    v_and_b32 v47, 0xffff0000, v55
    v_pk_add_f32 v[16:17], v[32:33], s[62:63]
    v_pk_add_f32 v[18:19], v[34:35], s[62:63]
    v_pk_add_f32 v[20:21], v[36:37], s[62:63]
    v_pk_add_f32 v[22:23], v[38:39], s[62:63]
    v_pk_add_f32 v[24:25], v[40:41], s[62:63]
    v_pk_add_f32 v[26:27], v[42:43], s[62:63]
    v_pk_add_f32 v[28:29], v[44:45], s[62:63]
    v_pk_add_f32 v[30:31], v[46:47], s[62:63]
    v_cvt_pk_bf16_f32 v80, v16, v17
    v_cvt_pk_bf16_f32 v81, v18, v19
    v_cvt_pk_bf16_f32 v82, v20, v21
    v_cvt_pk_bf16_f32 v83, v22, v23
    v_cvt_pk_bf16_f32 v84, v24, v25
    v_cvt_pk_bf16_f32 v85, v26, v27
    v_cvt_pk_bf16_f32 v86, v28, v29
    v_cvt_pk_bf16_f32 v87, v30, v31
    s_lshl_b32 s32, s25, 3
    s_lshl_b32 s33, s40, 1
    s_add_u32 s32, s32, s33
    s_add_u32 s32, s32, 1
    s_lshl_b32 s32, s32, 5
    s_add_u32 s32, s32, s42
    s_lshl_b32 s32, s32, 11
    buffer_store_dwordx4 v[80:83], v12, s[16:19], s32 offen sc1
    buffer_store_dwordx4 v[84:87], v12, s[16:19], s32 offen offset:1024 sc1
    s_cmp_lg_u32 s24, 0
    s_cbranch_scc1 L_noat2_4
    s_waitcnt vmcnt(4)
    s_mov_b64 exec, 1
    v_mov_b32 v15, 0
    ds_write_b32 v15, v14
    s_waitcnt lgkmcnt(0)
    s_mov_b64 exec, -1
    s_nop 0
L_noat2_4:
    s_barrier
    v_mov_b32 v15, 0
    ds_read_b32 v14, v15
    s_waitcnt lgkmcnt(0)
    v_readfirstlane_b32 s32, v14
    s_nop 0
    s_cmp_lg_u32 s32, 7
    s_cbranch_scc1 L_exit
    s_cmp_ge_u32 s24, 4
    s_cbranch_scc1 L_exit
    s_mul_i32 s33, s42, 36864
    s_add_u32 s33, s33, 4194304
    v_and_b32 v13, 15, v1
    v_cmp_gt_u32 vcc, 8, v13
    v_mul_u32_u24 v13, 4608, v13
    v_lshrrev_b32 v14, 4, v1
    v_lshl_add_u32 v13, v14, 4, v13
    v_mov_b32 v15, 0x40000000
    v_cndmask_b32 v13, v15, v13, vcc
    s_lshl_b32 s34, s40, 6
    s_add_u32 s34, s34, s33
    s_add_u32 s34, s34, 4096
    buffer_load_dwordx4 v[16:19], v13, s[16:19], s34 offen sc1
    s_lshl_b32 s34, s40, 11
    s_add_u32 s33, s33, s34
    buffer_load_dwordx4 v[96:99], v12, s[16:19], s33 offen offset:0 sc1
    buffer_load_dwordx4 v[100:103], v12, s[16:19], s33 offen offset:1024 sc1
    s_add_u32 s33, s33, 4608
    buffer_load_dwordx4 v[104:107], v12, s[16:19], s33 offen offset:0 sc1
    buffer_load_dwordx4 v[108:111], v12, s[16:19], s33 offen offset:1024 sc1
    s_add_u32 s33, s33, 4608
    buffer_load_dwordx4 v[112:115], v12, s[16:19], s33 offen offset:0 sc1
    buffer_load_dwordx4 v[116:119], v12, s[16:19], s33 offen offset:1024 sc1
    s_add_u32 s33, s33, 4608
    buffer_load_dwordx4 v[120:123], v12, s[16:19], s33 offen offset:0 sc1
    buffer_load_dwordx4 v[124:127], v12, s[16:19], s33 offen offset:1024 sc1
    s_add_u32 s33, s33, 4608
    buffer_load_dwordx4 v[128:131], v12, s[16:19], s33 offen offset:0 sc1
    buffer_load_dwordx4 v[132:135], v12, s[16:19], s33 offen offset:1024 sc1
    s_add_u32 s33, s33, 4608
    buffer_load_dwordx4 v[136:139], v12, s[16:19], s33 offen offset:0 sc1
    buffer_load_dwordx4 v[140:143], v12, s[16:19], s33 offen offset:1024 sc1
    s_add_u32 s33, s33, 4608
    buffer_load_dwordx4 v[144:147], v12, s[16:19], s33 offen offset:0 sc1
    buffer_load_dwordx4 v[148:151], v12, s[16:19], s33 offen offset:1024 sc1
    s_add_u32 s33, s33, 4608
    buffer_load_dwordx4 v[152:155], v12, s[16:19], s33 offen offset:0 sc1
    buffer_load_dwordx4 v[156:159], v12, s[16:19], s33 offen offset:1024 sc1
    s_waitcnt vmcnt(16)
    v_add_f32_dpp v16, v16, v16 row_ror:8 row_mask:0xf bank_mask:0xf
    v_add_f32_dpp v17, v17, v17 row_ror:8 row_mask:0xf bank_mask:0xf
    v_add_f32_dpp v18, v18, v18 row_ror:8 row_mask:0xf bank_mask:0xf
    v_add_f32_dpp v19, v19, v19 row_ror:8 row_mask:0xf bank_mask:0xf
    v_add_f32_dpp v16, v16, v16 row_ror:4 row_mask:0xf bank_mask:0xf
    v_add_f32_dpp v17, v17, v17 row_ror:4 row_mask:0xf bank_mask:0xf
    v_add_f32_dpp v18, v18, v18 row_ror:4 row_mask:0xf bank_mask:0xf
    v_add_f32_dpp v19, v19, v19 row_ror:4 row_mask:0xf bank_mask:0xf
    v_add_f32_dpp v16, v16, v16 row_ror:2 row_mask:0xf bank_mask:0xf
    v_add_f32_dpp v17, v17, v17 row_ror:2 row_mask:0xf bank_mask:0xf
    v_add_f32_dpp v18, v18, v18 row_ror:2 row_mask:0xf bank_mask:0xf
    v_add_f32_dpp v19, v19, v19 row_ror:2 row_mask:0xf bank_mask:0xf
    v_add_f32_dpp v16, v16, v16 row_ror:1 row_mask:0xf bank_mask:0xf
    v_add_f32_dpp v17, v17, v17 row_ror:1 row_mask:0xf bank_mask:0xf
    v_add_f32_dpp v18, v18, v18 row_ror:1 row_mask:0xf bank_mask:0xf
    v_add_f32_dpp v19, v19, v19 row_ror:1 row_mask:0xf bank_mask:0xf
    v_cvt_pk_bf16_f32 v20, v16, v17
    v_cvt_pk_bf16_f32 v21, v18, v19
    v_and_b32 v13, 1, v14
    v_lshlrev_b32 v13, 4, v13
    v_lshrrev_b32 v14, 1, v14
    v_lshl_add_u32 v13, v14, 3, v13
    s_lshl_b32 s34, s42, 6
    s_lshl_b32 s35, s40, 5
    s_add_u32 s34, s34, s35
    s_add_u32 s34, s34, 7405568
    s_mov_b32 exec_lo, 0x00010001
    s_mov_b32 exec_hi, 0x00010001
    buffer_store_dwordx2 v[20:21], v13, s[16:19], s34 offen
    s_mov_b64 exec, -1
    s_waitcnt vmcnt(1)
    v_add_f32 v96, v96, v104
    v_add_f32 v97, v97, v105
    v_add_f32 v98, v98, v106
    v_add_f32 v99, v99, v107
    v_add_f32 v100, v100, v108
    v_add_f32 v101, v101, v109
    v_add_f32 v102, v102, v110
    v_add_f32 v103, v103, v111
    v_add_f32 v96, v96, v112
    v_add_f32 v97, v97, v113
    v_add_f32 v98, v98, v114
    v_add_f32 v99, v99, v115
    v_add_f32 v100, v100, v116
    v_add_f32 v101, v101, v117
    v_add_f32 v102, v102, v118
    v_add_f32 v103, v103, v119
    v_add_f32 v96, v96, v120
    v_add_f32 v97, v97, v121
    v_add_f32 v98, v98, v122
    v_add_f32 v99, v99, v123
    v_add_f32 v100, v100, v124
    v_add_f32 v101, v101, v125
    v_add_f32 v102, v102, v126
    v_add_f32 v103, v103, v127
    v_add_f32 v96, v96, v128
    v_add_f32 v97, v97, v129
    v_add_f32 v98, v98, v130
    v_add_f32 v99, v99, v131
    v_add_f32 v100, v100, v132
    v_add_f32 v101, v101, v133
    v_add_f32 v102, v102, v134
    v_add_f32 v103, v103, v135
    v_add_f32 v96, v96, v136
    v_add_f32 v97, v97, v137
    v_add_f32 v98, v98, v138
    v_add_f32 v99, v99, v139
    v_add_f32 v100, v100, v140
    v_add_f32 v101, v101, v141
    v_add_f32 v102, v102, v142
    v_add_f32 v103, v103, v143
    v_add_f32 v96, v96, v144
    v_add_f32 v97, v97, v145
    v_add_f32 v98, v98, v146
    v_add_f32 v99, v99, v147
    v_add_f32 v100, v100, v148
    v_add_f32 v101, v101, v149
    v_add_f32 v102, v102, v150
    v_add_f32 v103, v103, v151
    v_add_f32 v96, v96, v152
    v_add_f32 v97, v97, v153
    v_add_f32 v98, v98, v154
    v_add_f32 v99, v99, v155
    v_add_f32 v100, v100, v156
    v_add_f32 v101, v101, v157
    v_add_f32 v102, v102, v158
    v_add_f32 v103, v103, v159
    v_cvt_pk_bf16_f32 v16, v96, v97
    v_cvt_pk_bf16_f32 v17, v98, v99
    v_cvt_pk_bf16_f32 v18, v100, v101
    v_cvt_pk_bf16_f32 v19, v102, v103
    s_lshl_b32 s33, s42, 1
    s_add_u32 s33, s33, s40
    s_lshl_b32 s33, s33, 10
    s_add_u32 s33, s33, 7340032
    buffer_store_dwordx4 v[16:19], v12, s[16:19], s33 offen
    s_branch L_exit
    s_nop 0
L_phase_bc:
    s_and_b32 s25, s3, 7
    s_lshl_b32 s25, s25, 4
    s_lshr_b32 s26, s3, 3
    s_add_u32 s25, s25, s26
    s_lshl_b32 s25, s25, 3
    s_add_u32 s25, s25, s24
    s_mov_b32 s44, s68
    s_and_b32 s45, s69, 0xffff
    s_mov_b32 s46, 262144
    s_mov_b32 s47, 0x00020000
    s_mov_b32 s48, s70
    s_and_b32 s49, s71, 0xffff
    s_mov_b32 s50, 262144
    s_mov_b32 s51, 0x00020000
    s_mov_b32 s52, s72
    s_and_b32 s53, s73, 0xffff
    s_mov_b32 s54, 262144
    s_mov_b32 s55, 0x00020000
    s_mov_b32 s56, s74
    s_and_b32 s57, s75, 0xffff
    s_mov_b32 s58, 262144
    s_mov_b32 s59, 0x00020000
    s_mov_b32 s64, s76
    s_and_b32 s65, s77, 0xffff
    s_mov_b32 s66, 2048
    s_mov_b32 s67, 0x00020000
    s_lshl_b32 s26, s25, 8
    v_lshlrev_b32 v2, 2, v1
    s_lshl_b32 s27, s25, 1
    v_mov_b32 v7, s27
    buffer_load_ushort v6, v7, s[64:67], 0 offen
    buffer_load_dword v8, v2, s[44:47], s26 offen
    buffer_load_dword v9, v2, s[48:51], s26 offen
    buffer_load_dword v10, v2, s[52:55], s26 offen
    buffer_load_dword v11, v2, s[56:59], s26 offen
    s_and_b32 s32, s3, 1
    s_lshl_b32 s32, s32, 21
    s_lshr_b32 s33, s3, 3
    s_lshl_b32 s33, s33, 3
    s_add_u32 s33, s33, s24
    s_lshl_b32 s34, s33, 14
    s_add_u32 s32, s32, s34
    v_lshrrev_b32 v40, 3, v1
    v_and_b32 v41, 7, v1
    v_lshlrev_b32 v42, 11, v40
    v_lshl_add_u32 v210, v41, 7, v42
    s_lshr_b32 s34, s3, 1
    s_and_b32 s34, s34, 3
    s_lshl_b32 s34, s34, 9
    s_mul_i32 s35, s33, 49152
    s_add_u32 s33, s34, s35
    v_mul_u32_u24 v42, 6144, v40
    v_and_b32 v43, 3, v1
    v_lshl_add_u32 v42, v43, 7, v42
    v_bfe_u32 v43, v1, 2, 1
    v_lshl_add_u32 v211, v43, 11, v42
    v_add_u32 v212, 4096, v42
    buffer_load_dword v214, v210, s[8:11], s32 offen
    buffer_load_dword v214, v211, s[12:15], s33 offen
    buffer_load_dword v214, v210, s[8:11], s32 offen offset:1024
    buffer_load_dword v214, v212, s[12:15], s33 offen
    s_load_dwordx4 s[68:71], s[0:1], 16
    s_load_dwordx4 s[72:75], s[0:1], 72
    s_mov_b32 s78, 1069066752
    s_mov_b32 s79, 921478512
    v_and_b32 v12, 15, v1
    v_cvt_f32_u32 v24, v12
    v_mov_b32 v25, v24
    v_mov_b32 v13, 0x41800000
    v_mul_f32 v26, v13, v24
    v_mov_b32 v27, v26
    s_mov_b32 s80, 0x0000bf80
    s_mov_b32 s81, 0xbf800000
    s_mov_b32 s82, 1069066811
    s_waitcnt vmcnt(4)
    v_lshlrev_b32 v6, 16, v6
    v_mul_f32 v14, s78, v6
    v_rndne_f32 v15, v14
    v_sub_f32 v14, v14, v15
    v_fma_f32 v14, v6, s79, v14
    v_exp_f32 v14, v14
    v_cvt_i32_f32 v15, v15
    v_ldexp_f32 v14, v14, v15
    v_cvt_pk_bf16_f32 v14, v14, v14
    v_and_b32 v6, 0xffff0000, v14
    v_lshlrev_b32 v128, 16, v8
    v_and_b32 v129, 0xffff0000, v8
    v_lshlrev_b32 v130, 16, v9
    v_and_b32 v131, 0xffff0000, v9
    v_lshlrev_b32 v132, 16, v10
    v_and_b32 v133, 0xffff0000, v10
    v_lshlrev_b32 v134, 16, v11
    v_and_b32 v135, 0xffff0000, v11
    v_mul_f32 v14, s78, v128
    v_rndne_f32 v15, v14
    v_sub_f32 v14, v14, v15
    v_fma_f32 v14, v128, s79, v14
    v_exp_f32 v14, v14
    v_cvt_i32_f32 v15, v15
    v_ldexp_f32 v14, v14, v15
    v_cvt_pk_bf16_f32 v14, v14, v14
    v_and_b32 v128, 0xffff0000, v14
    v_mul_f32 v16, s78, v129
    v_rndne_f32 v17, v16
    v_sub_f32 v16, v16, v17
    v_fma_f32 v16, v129, s79, v16
    v_exp_f32 v16, v16
    v_cvt_i32_f32 v17, v17
    v_ldexp_f32 v16, v16, v17
    v_cvt_pk_bf16_f32 v16, v16, v16
    v_and_b32 v129, 0xffff0000, v16
    v_mul_f32 v128, v128, v6
    v_mul_f32 v128, s82, v128
    v_sub_f32 v128, 0, v128
    v_mul_f32 v130, v130, v6
    v_mul_f32 v130, 0.15915494, v130
    v_mul_f32 v132, v132, v6
    v_add_f32 v132, v132, v132
    v_mul_f32 v134, v134, v6
    v_add_f32 v134, v134, v134
    v_mul_f32 v129, v129, v6
    v_mul_f32 v129, s82, v129
    v_sub_f32 v129, 0, v129
    v_mul_f32 v131, v131, v6
    v_mul_f32 v131, 0.15915494, v131
    v_mul_f32 v133, v133, v6
    v_add_f32 v133, v133, v133
    v_mul_f32 v135, v135, v6
    v_add_f32 v135, v135, v135
    v_max3_f32 v14, |v132|, |v133|, |v134|
    v_max3_f32 v14, |v135|, v14, v14
    s_nop 1
    v_max_f32_dpp v14, v14, v14 row_ror:8 row_mask:0xf bank_mask:0xf
    s_nop 1
    v_max_f32_dpp v14, v14, v14 row_ror:4 row_mask:0xf bank_mask:0xf
    s_nop 1
    v_max_f32_dpp v14, v14, v14 row_ror:2 row_mask:0xf bank_mask:0xf
    s_nop 1
    v_max_f32_dpp v14, v14, v14 row_ror:1 row_mask:0xf bank_mask:0xf
    s_nop 0
    v_readlane_b32 s40, v14, 0
    v_readlane_b32 s41, v14, 16
    v_readlane_b32 s42, v14, 32
    v_readlane_b32 s43, v14, 48
    s_max_u32 s40, s40, s41
    s_max_u32 s42, s42, s43
    s_max_u32 s40, s40, s42
    s_lshr_b32 s40, s40, 23
    s_sub_u32 s40, 267, s40
    s_min_u32 s40, s40, 253
    s_max_u32 s40, s40, 1
    s_sub_u32 s41, 254, s40
    s_lshl_b32 s83, s40, 23
    s_lshl_b32 s29, s41, 23
    v_mul_f32 v132, s83, v132
    v_mul_f32 v133, s83, v133
    v_mul_f32 v134, s83, v134
    v_mul_f32 v135, s83, v135
    s_mov_b32 s65, s29
    s_waitcnt lgkmcnt(0)
    s_mov_b32 s44, s70
    s_and_b32 s45, s71, 0xffff
    s_mov_b32 s46, 4194304
    s_mov_b32 s47, 0x00020000
    s_mov_b32 s8, s74
    s_and_b32 s9, s75, 0xffff
    s_mov_b32 s10, 8388608
    s_mov_b32 s11, 0x00020000
    s_mov_b32 s12, s68
    s_and_b32 s13, s69, 0xffff
    s_mov_b32 s14, 2097152
    s_mov_b32 s15, 0x00020000
    s_lshl_b32 s36, s3, 3
    s_add_u32 s36, s36, s24
    s_lshl_b32 s36, s36, 11
    v_lshlrev_b32 v220, 7, v1
    s_mov_b64 exec, 0xffff
    buffer_load_dword v221, v220, s[12:15], s36 offen
    s_mov_b64 exec, -1
    s_and_b32 s25, s3, 7
    s_lshl_b32 s25, s25, 4
    s_lshr_b32 s26, s3, 3
    s_add_u32 s25, s25, s26
    s_lshl_b32 s26, s25, 4
    v_lshlrev_b32 v2, 13, v0
    v_add_u32 v2, s26, v2
    v_subrev_u32 v3, 2048, v2
    v_cmp_eq_u32 vcc, 0, v0
    v_mov_b32 v4, 0x40000000
    s_nop 0
    v_cndmask_b32 v3, v3, v4, vcc
    buffer_load_dwordx4 v[164:167], v3, s[44:47], 0 offen
    s_mov_b32 s28, 4096
    buffer_load_dwordx4 v[168:171], v2, s[44:47], 0 offen offset:0
    buffer_load_dwordx4 v[172:175], v2, s[44:47], 0 offen offset:2048
    buffer_load_dwordx4 v[176:179], v2, s[44:47], s28 offen offset:0
    buffer_load_dwordx4 v[180:183], v2, s[44:47], s28 offen offset:2048
    s_mov_b32 s56, s26
    v_and_b32 v12, 15, v1
    v_cvt_f32_u32 v24, v12
    v_mov_b32 v25, v24
    v_mov_b32 v13, 0x41800000
    v_mul_f32 v26, v13, v24
    v_mov_b32 v27, v26
    s_mov_b32 s80, 0x0000bf80
    s_mov_b32 s81, 0xbf800000
    s_lshl_b32 s27, s24, 11
    s_add_u32 s27, s27, 131072
    v_lshlrev_b32 v2, 3, v1
    v_add_u32 v2, s27, v2
    ds_write_b64 v2, v[128:129] offset:0
    ds_write_b64 v2, v[130:131] offset:512
    ds_write_b64 v2, v[132:133] offset:1024
    ds_write_b64 v2, v[134:135] offset:1536
    v_mov_b32 v242, v128
    v_mov_b32 v243, v129
    v_mov_b32 v244, v130
    v_mov_b32 v245, v131
    v_mov_b32 v246, v132
    v_mov_b32 v247, v133
    v_mov_b32 v248, v134
    v_mov_b32 v249, v135
    v_lshrrev_b32 v3, 4, v1
    v_lshlrev_b32 v3, 4, v3
    v_add_u32 v3, s27, v3
    v_mov_b32 v32, 0
    v_mov_b32 v33, 0
    v_mov_b32 v34, 0
    v_mov_b32 v35, 0
    v_mov_b32 v36, 0
    v_mov_b32 v37, 0
    v_mov_b32 v38, 0
    v_mov_b32 v39, 0
    v_mov_b32 v40, 0
    v_mov_b32 v41, 0
    v_mov_b32 v42, 0
    v_mov_b32 v43, 0
    v_mov_b32 v44, 0
    v_mov_b32 v45, 0
    v_mov_b32 v46, 0
    v_mov_b32 v47, 0
    v_mov_b32 v28, 0
    v_mov_b32 v29, 0
    s_mov_b32 s28, 0
    s_waitcnt lgkmcnt(0)
    s_nop 0
L_kg_5:
    ds_read_b128 v[8:11], v3 offset:0
    ds_read_b128 v[12:15], v3 offset:512
    ds_read_b128 v[16:19], v3 offset:1024
    ds_read_b128 v[20:23], v3 offset:1536
    v_add_u32 v3, 64, v3
    s_waitcnt lgkmcnt(0)
    v_pk_mul_f32 v[48:49], v[8:9], v[24:25]
    v_pk_mul_f32 v[136:137], v[10:11], v[24:25]
    v_pk_mul_f32 v[56:57], v[8:9], v[26:27]
    v_pk_mul_f32 v[144:145], v[10:11], v[26:27]
    v_pk_mul_f32 v[50:51], v[12:13], v[24:25]
    v_pk_mul_f32 v[138:139], v[14:15], v[24:25]
    v_pk_mul_f32 v[58:59], v[12:13], v[26:27]
    v_pk_mul_f32 v[146:147], v[14:15], v[26:27]
    v_exp_f32 v48, v48
    v_exp_f32 v136, v136
    v_exp_f32 v56, v56
    v_exp_f32 v144, v144
    v_exp_f32 v49, v49
    v_exp_f32 v137, v137
    v_exp_f32 v57, v57
    v_exp_f32 v145, v145
    v_fract_f32 v50, v50
    v_fract_f32 v138, v138
    v_fract_f32 v58, v58
    v_fract_f32 v146, v146
    v_fract_f32 v51, v51
    v_fract_f32 v139, v139
    v_fract_f32 v59, v59
    v_fract_f32 v147, v147
    v_cos_f32 v52, v50
    v_cos_f32 v140, v138
    v_cos_f32 v60, v58
    v_cos_f32 v148, v146
    v_cos_f32 v53, v51
    v_cos_f32 v141, v139
    v_cos_f32 v61, v59
    v_cos_f32 v149, v147
    v_sin_f32 v54, v50
    v_sin_f32 v142, v138
    v_sin_f32 v62, v58
    v_sin_f32 v150, v146
    v_sin_f32 v55, v51
    v_sin_f32 v143, v139
    v_sin_f32 v63, v59
    v_sin_f32 v151, v147
    v_pk_mul_f32 v[128:129], v[48:49], v[52:53]
    v_pk_mul_f32 v[152:153], v[136:137], v[140:141]
    v_pk_mul_f32 v[132:133], v[56:57], v[60:61]
    v_pk_mul_f32 v[156:157], v[144:145], v[148:149]
    v_pk_mul_f32 v[130:131], v[48:49], v[54:55]
    v_pk_mul_f32 v[154:155], v[136:137], v[142:143]
    v_pk_mul_f32 v[134:135], v[56:57], v[62:63]
    v_pk_mul_f32 v[158:159], v[144:145], v[150:151]
    v_pk_mul_f32 v[52:53], v[20:21], v[134:135]
    v_pk_mul_f32 v[140:141], v[22:23], v[158:159]
    v_pk_mul_f32 v[54:55], v[20:21], v[132:133]
    v_pk_mul_f32 v[142:143], v[22:23], v[156:157]
    v_pk_fma_f32 v[56:57], v[16:17], v[132:133], v[52:53] neg_lo:[0,0,1] neg_hi:[0,0,1]
    v_pk_fma_f32 v[144:145], v[18:19], v[156:157], v[140:141] neg_lo:[0,0,1] neg_hi:[0,0,1]
    v_pk_fma_f32 v[58:59], v[16:17], v[134:135], v[54:55] neg_lo:[1,0,1] neg_hi:[1,0,1]
    v_pk_fma_f32 v[146:147], v[18:19], v[158:159], v[142:143] neg_lo:[1,0,1] neg_hi:[1,0,1]
    v_cvt_pk_f16_f32 v64, v128, v129
    v_cvt_pk_f16_f32 v66, v152, v153
    v_cvt_pk_f16_f32 v65, v130, v131
    v_cvt_pk_f16_f32 v67, v154, v155
    v_cvt_pk_f16_f32 v72, v56, v57
    v_cvt_pk_f16_f32 v74, v144, v145
    v_cvt_pk_f16_f32 v73, v58, v59
    v_cvt_pk_f16_f32 v75, v146, v147
    v_pk_mul_f32 v[48:49], v[130:131], v[130:131]
    v_pk_mul_f32 v[136:137], v[154:155], v[154:155]
    v_pk_add_f32 v[50:51], v[128:129], v[128:129]
    v_pk_add_f32 v[138:139], v[152:153], v[152:153]
    v_pk_fma_f32 v[128:129], v[128:129], v[128:129], v[48:49] neg_lo:[0,0,1] neg_hi:[0,0,1]
    v_pk_fma_f32 v[152:153], v[152:153], v[152:153], v[136:137] neg_lo:[0,0,1] neg_hi:[0,0,1]
    v_pk_mul_f32 v[130:131], v[50:51], v[130:131]
    v_pk_mul_f32 v[154:155], v[138:139], v[154:155]
    v_pk_mul_f32 v[52:53], v[134:135], v[134:135]
    v_pk_mul_f32 v[140:141], v[158:159], v[158:159]
    v_pk_add_f32 v[54:55], v[132:133], v[132:133]
    v_pk_add_f32 v[142:143], v[156:157], v[156:157]
    v_pk_fma_f32 v[132:133], v[132:133], v[132:133], v[52:53] neg_lo:[0,0,1] neg_hi:[0,0,1]
    v_pk_fma_f32 v[156:157], v[156:157], v[156:157], v[140:141] neg_lo:[0,0,1] neg_hi:[0,0,1]
    v_pk_mul_f32 v[134:135], v[54:55], v[134:135]
    v_pk_mul_f32 v[158:159], v[142:143], v[158:159]
    v_pk_mul_f32 v[52:53], v[20:21], v[134:135]
    v_pk_mul_f32 v[140:141], v[22:23], v[158:159]
    v_pk_mul_f32 v[54:55], v[20:21], v[132:133]
    v_pk_mul_f32 v[142:143], v[22:23], v[156:157]
    v_pk_fma_f32 v[56:57], v[16:17], v[132:133], v[52:53] neg_lo:[0,0,1] neg_hi:[0,0,1]
    v_pk_fma_f32 v[144:145], v[18:19], v[156:157], v[140:141] neg_lo:[0,0,1] neg_hi:[0,0,1]
    v_pk_fma_f32 v[58:59], v[16:17], v[134:135], v[54:55] neg_lo:[1,0,1] neg_hi:[1,0,1]
    v_pk_fma_f32 v[146:147], v[18:19], v[158:159], v[142:143] neg_lo:[1,0,1] neg_hi:[1,0,1]
    v_cvt_pk_f16_f32 v80, v128, v129
    v_cvt_pk_f16_f32 v82, v152, v153
    v_cvt_pk_f16_f32 v81, v130, v131
    v_cvt_pk_f16_f32 v83, v154, v155
    v_cvt_pk_f16_f32 v88, v56, v57
    v_cvt_pk_f16_f32 v90, v144, v145
    v_cvt_pk_f16_f32 v89, v58, v59
    v_cvt_pk_f16_f32 v91, v146, v147
    v_pk_mul_f32 v[48:49], v[130:131], v[130:131]
    v_pk_mul_f32 v[136:137], v[154:155], v[154:155]
    v_pk_add_f32 v[50:51], v[128:129], v[128:129]
    v_pk_add_f32 v[138:139], v[152:153], v[152:153]
    v_pk_fma_f32 v[128:129], v[128:129], v[128:129], v[48:49] neg_lo:[0,0,1] neg_hi:[0,0,1]
    v_pk_fma_f32 v[152:153], v[152:153], v[152:153], v[136:137] neg_lo:[0,0,1] neg_hi:[0,0,1]
    v_pk_mul_f32 v[130:131], v[50:51], v[130:131]
    v_pk_mul_f32 v[154:155], v[138:139], v[154:155]
    v_pk_mul_f32 v[52:53], v[134:135], v[134:135]
    v_pk_mul_f32 v[140:141], v[158:159], v[158:159]
    v_pk_add_f32 v[54:55], v[132:133], v[132:133]
    v_pk_add_f32 v[142:143], v[156:157], v[156:157]
    v_pk_fma_f32 v[132:133], v[132:133], v[132:133], v[52:53] neg_lo:[0,0,1] neg_hi:[0,0,1]
    v_pk_fma_f32 v[156:157], v[156:157], v[156:157], v[140:141] neg_lo:[0,0,1] neg_hi:[0,0,1]
    v_pk_mul_f32 v[134:135], v[54:55], v[134:135]
    v_pk_mul_f32 v[158:159], v[142:143], v[158:159]
    v_pk_mul_f32 v[52:53], v[20:21], v[134:135]
    v_pk_mul_f32 v[140:141], v[22:23], v[158:159]
    v_pk_mul_f32 v[54:55], v[20:21], v[132:133]
    v_pk_mul_f32 v[142:143], v[22:23], v[156:157]
    v_pk_fma_f32 v[56:57], v[16:17], v[132:133], v[52:53] neg_lo:[0,0,1] neg_hi:[0,0,1]
    v_pk_fma_f32 v[144:145], v[18:19], v[156:157], v[140:141] neg_lo:[0,0,1] neg_hi:[0,0,1]
    v_pk_fma_f32 v[58:59], v[16:17], v[134:135], v[54:55] neg_lo:[1,0,1] neg_hi:[1,0,1]
    v_pk_fma_f32 v[146:147], v[18:19], v[158:159], v[142:143] neg_lo:[1,0,1] neg_hi:[1,0,1]
    v_cvt_pk_f16_f32 v96, v128, v129
    v_cvt_pk_f16_f32 v98, v152, v153
    v_cvt_pk_f16_f32 v97, v130, v131
    v_cvt_pk_f16_f32 v99, v154, v155
    v_cvt_pk_f16_f32 v104, v56, v57
    v_cvt_pk_f16_f32 v106, v144, v145
    v_cvt_pk_f16_f32 v105, v58, v59
    v_cvt_pk_f16_f32 v107, v146, v147
    v_pk_mul_f32 v[48:49], v[130:131], v[130:131]
    v_pk_mul_f32 v[136:137], v[154:155], v[154:155]
    v_pk_add_f32 v[50:51], v[128:129], v[128:129]
    v_pk_add_f32 v[138:139], v[152:153], v[152:153]
    v_pk_fma_f32 v[128:129], v[128:129], v[128:129], v[48:49] neg_lo:[0,0,1] neg_hi:[0,0,1]
    v_pk_fma_f32 v[152:153], v[152:153], v[152:153], v[136:137] neg_lo:[0,0,1] neg_hi:[0,0,1]
    v_pk_mul_f32 v[130:131], v[50:51], v[130:131]
    v_pk_mul_f32 v[154:155], v[138:139], v[154:155]
    v_pk_mul_f32 v[52:53], v[134:135], v[134:135]
    v_pk_mul_f32 v[140:141], v[158:159], v[158:159]
    v_pk_add_f32 v[54:55], v[132:133], v[132:133]
    v_pk_add_f32 v[142:143], v[156:157], v[156:157]
    v_pk_fma_f32 v[132:133], v[132:133], v[132:133], v[52:53] neg_lo:[0,0,1] neg_hi:[0,0,1]
    v_pk_fma_f32 v[156:157], v[156:157], v[156:157], v[140:141] neg_lo:[0,0,1] neg_hi:[0,0,1]
    v_pk_mul_f32 v[134:135], v[54:55], v[134:135]
    v_pk_mul_f32 v[158:159], v[142:143], v[158:159]
    v_pk_mul_f32 v[52:53], v[20:21], v[134:135]
    v_pk_mul_f32 v[140:141], v[22:23], v[158:159]
    v_pk_mul_f32 v[54:55], v[20:21], v[132:133]
    v_pk_mul_f32 v[142:143], v[22:23], v[156:157]
    v_pk_fma_f32 v[56:57], v[16:17], v[132:133], v[52:53] neg_lo:[0,0,1] neg_hi:[0,0,1]
    v_pk_fma_f32 v[144:145], v[18:19], v[156:157], v[140:141] neg_lo:[0,0,1] neg_hi:[0,0,1]
    v_pk_fma_f32 v[58:59], v[16:17], v[134:135], v[54:55] neg_lo:[1,0,1] neg_hi:[1,0,1]
    v_pk_fma_f32 v[146:147], v[18:19], v[158:159], v[142:143] neg_lo:[1,0,1] neg_hi:[1,0,1]
    v_cvt_pk_f16_f32 v112, v128, v129
    v_cvt_pk_f16_f32 v114, v152, v153
    v_cvt_pk_f16_f32 v113, v130, v131
    v_cvt_pk_f16_f32 v115, v154, v155
    v_cvt_pk_f16_f32 v120, v56, v57
    v_cvt_pk_f16_f32 v122, v144, v145
    v_cvt_pk_f16_f32 v121, v58, v59
    v_cvt_pk_f16_f32 v123, v146, v147
    v_pk_mul_f32 v[52:53], v[134:135], v[134:135]
    v_pk_mul_f32 v[140:141], v[158:159], v[158:159]
    v_pk_add_f32 v[54:55], v[132:133], v[132:133]
    v_pk_add_f32 v[142:143], v[156:157], v[156:157]
    v_pk_fma_f32 v[132:133], v[132:133], v[132:133], v[52:53] neg_lo:[0,0,1] neg_hi:[0,0,1]
    v_pk_fma_f32 v[156:157], v[156:157], v[156:157], v[140:141] neg_lo:[0,0,1] neg_hi:[0,0,1]
    v_pk_mul_f32 v[134:135], v[54:55], v[134:135]
    v_pk_mul_f32 v[158:159], v[142:143], v[158:159]
    v_pk_fma_f32 v[28:29], v[16:17], v[132:133], v[28:29]
    v_pk_fma_f32 v[28:29], v[18:19], v[156:157], v[28:29]
    v_pk_fma_f32 v[28:29], v[20:21], v[134:135], v[28:29] neg_lo:[1,0,0] neg_hi:[1,0,0]
    v_pk_fma_f32 v[28:29], v[22:23], v[158:159], v[28:29] neg_lo:[1,0,0] neg_hi:[1,0,0]
    v_mfma_f32_16x16x32_f16 v[32:35], v[72:75], v[64:67], v[32:35]
    v_mfma_f32_16x16x32_f16 v[36:39], v[88:91], v[80:83], v[36:39]
    v_mfma_f32_16x16x32_f16 v[40:43], v[104:107], v[96:99], v[40:43]
    v_mfma_f32_16x16x32_f16 v[44:47], v[120:123], v[112:115], v[44:47]
    s_add_u32 s28, s28, 1
    s_cmp_lt_u32 s28, 8
    s_cbranch_scc1 L_kg_5
    s_mov_b32 s29, s65
    s_nop 0
    v_mul_f32 v32, s29, v32
    v_mul_f32 v33, s29, v33
    v_mul_f32 v34, s29, v34
    v_mul_f32 v35, s29, v35
    v_mul_f32 v36, s29, v36
    v_mul_f32 v37, s29, v37
    v_mul_f32 v38, s29, v38
    v_mul_f32 v39, s29, v39
    v_mul_f32 v40, s29, v40
    v_mul_f32 v41, s29, v41
    v_mul_f32 v42, s29, v42
    v_mul_f32 v43, s29, v43
    v_mul_f32 v44, s29, v44
    v_mul_f32 v45, s29, v45
    v_mul_f32 v46, s29, v46
    v_mul_f32 v47, s29, v47
    v_cvt_pk_bf16_f32 v224, v32, v32
    v_cvt_pk_bf16_f32 v225, v33, v33
    v_cvt_pk_bf16_f32 v226, v34, v34
    v_cvt_pk_bf16_f32 v227, v35, v35
    v_cvt_pk_bf16_f32 v228, v36, v36
    v_cvt_pk_bf16_f32 v229, v37, v37
    v_cvt_pk_bf16_f32 v230, v38, v38
    v_cvt_pk_bf16_f32 v231, v39, v39
    v_cvt_pk_bf16_f32 v232, v40, v40
    v_cvt_pk_bf16_f32 v233, v41, v41
    v_cvt_pk_bf16_f32 v234, v42, v42
    v_cvt_pk_bf16_f32 v235, v43, v43
    v_cvt_pk_bf16_f32 v236, v44, v44
    v_cvt_pk_bf16_f32 v237, v45, v45
    v_cvt_pk_bf16_f32 v238, v46, v46
    v_cvt_pk_bf16_f32 v239, v47, v47
    v_add_f32 v28, v28, v29
    s_nop 0
    v_readlane_b32 s40, v28, 8
    v_readlane_b32 s41, v28, 24
    v_readlane_b32 s42, v28, 40
    v_readlane_b32 s43, v28, 56
    v_mov_b32 v28, s40
    v_add_f32 v28, s41, v28
    v_add_f32 v28, s42, v28
    v_add_f32 v28, s43, v28
    v_mul_f32 v28, s29, v28
    v_cvt_pk_bf16_f32 v240, v28, v28
    s_mov_b32 s26, s56
    s_load_dwordx4 s[48:51], s[72:73], s26
    s_mul_i32 s32, s24, 16384
    v_lshrrev_b32 v2, 4, v1
    v_lshlrev_b32 v2, 8, v2
    v_and_b32 v3, 15, v1
    v_lshl_add_u32 v2, v3, 2, v2
    v_add_u32 v2, s32, v2
    ds_write_b32 v2, v224 offset:13568
    ds_write_b32 v2, v225 offset:13632
    ds_write_b32 v2, v226 offset:13696
    ds_write_b32 v2, v227 offset:13760
    s_mov_b32 exec_lo, 0
    ds_write_b32 v2, v228 offset:14080
    ds_write_b32 v2, v229 offset:14144
    ds_write_b32 v2, v230 offset:14208
    ds_write_b32 v2, v231 offset:14272
    ds_write_b32 v2, v232 offset:14592
    ds_write_b32 v2, v233 offset:14656
    ds_write_b32 v2, v234 offset:14720
    ds_write_b32 v2, v235 offset:14784
    ds_write_b32 v2, v236 offset:15104
    ds_write_b32 v2, v237 offset:15168
    ds_write_b32 v2, v238 offset:15232
    ds_write_b32 v2, v239 offset:15296
    s_mov_b64 exec, 1
    ds_write_b32 v2, v240 offset:16128
    s_mov_b64 exec, -1
    v_lshlrev_b32 v6, 4, v1
    v_lshlrev_b32 v5, 2, v1
    s_add_u32 s33, s32, -54528
    v_sub_u32 v40, 2047, v5
    v_sub_u32 v41, 2046, v5
    v_sub_u32 v42, 2045, v5
    v_sub_u32 v43, 2044, v5
    v_cvt_f32_u32 v40, v40
    v_cvt_f32_u32 v41, v41
    v_cvt_f32_u32 v42, v42
    v_cvt_f32_u32 v43, v43
    v_cvt_pk_bf16_f32 v44, v40, v41
    v_cvt_pk_bf16_f32 v45, v42, v43
    v_and_b32 v40, 0xffff, v44
    v_lshrrev_b32 v41, 16, v44
    v_and_b32 v42, 0xffff, v45
    v_lshrrev_b32 v43, 16, v45
    v_lshl_add_u32 v128, v40, 2, s33
    v_lshl_add_u32 v129, v41, 2, s33
    v_lshl_add_u32 v130, v42, 2, s33
    v_lshl_add_u32 v131, v43, 2, s33
    v_sub_u32 v40, 1791, v5
    v_sub_u32 v41, 1790, v5
    v_sub_u32 v42, 1789, v5
    v_sub_u32 v43, 1788, v5
    v_cvt_f32_u32 v40, v40
    v_cvt_f32_u32 v41, v41
    v_cvt_f32_u32 v42, v42
    v_cvt_f32_u32 v43, v43
    v_cvt_pk_bf16_f32 v44, v40, v41
    v_cvt_pk_bf16_f32 v45, v42, v43
    v_and_b32 v40, 0xffff, v44
    v_lshrrev_b32 v41, 16, v44
    v_and_b32 v42, 0xffff, v45
    v_lshrrev_b32 v43, 16, v45
    v_lshl_add_u32 v132, v40, 2, s33
    v_lshl_add_u32 v133, v41, 2, s33
    v_lshl_add_u32 v134, v42, 2, s33
    v_lshl_add_u32 v135, v43, 2, s33
    v_sub_u32 v40, 1535, v5
    v_sub_u32 v41, 1534, v5
    v_sub_u32 v42, 1533, v5
    v_sub_u32 v43, 1532, v5
    v_cvt_f32_u32 v40, v40
    v_cvt_f32_u32 v41, v41
    v_cvt_f32_u32 v42, v42
    v_cvt_f32_u32 v43, v43
    v_cvt_pk_bf16_f32 v44, v40, v41
    v_cvt_pk_bf16_f32 v45, v42, v43
    v_and_b32 v40, 0xffff, v44
    v_lshrrev_b32 v41, 16, v44
    v_and_b32 v42, 0xffff, v45
    v_lshrrev_b32 v43, 16, v45
    v_lshl_add_u32 v136, v40, 2, s33
    v_lshl_add_u32 v137, v41, 2, s33
    v_lshl_add_u32 v138, v42, 2, s33
    v_lshl_add_u32 v139, v43, 2, s33
    v_sub_u32 v40, 1279, v5
    v_sub_u32 v41, 1278, v5
    v_sub_u32 v42, 1277, v5
    v_sub_u32 v43, 1276, v5
    v_cvt_f32_u32 v40, v40
    v_cvt_f32_u32 v41, v41
    v_cvt_f32_u32 v42, v42
    v_cvt_f32_u32 v43, v43
    v_cvt_pk_bf16_f32 v44, v40, v41
    v_cvt_pk_bf16_f32 v45, v42, v43
    v_and_b32 v40, 0xffff, v44
    v_lshrrev_b32 v41, 16, v44
    v_and_b32 v42, 0xffff, v45
    v_lshrrev_b32 v43, 16, v45
    v_lshl_add_u32 v140, v40, 2, s33
    v_lshl_add_u32 v141, v41, 2, s33
    v_lshl_add_u32 v142, v42, 2, s33
    v_lshl_add_u32 v143, v43, 2, s33
    v_sub_u32 v40, 1023, v5
    v_sub_u32 v41, 1022, v5
    v_sub_u32 v42, 1021, v5
    v_sub_u32 v43, 1020, v5
    v_cvt_f32_u32 v40, v40
    v_cvt_f32_u32 v41, v41
    v_cvt_f32_u32 v42, v42
    v_cvt_f32_u32 v43, v43
    v_cvt_pk_bf16_f32 v44, v40, v41
    v_cvt_pk_bf16_f32 v45, v42, v43
    v_and_b32 v40, 0xffff, v44
    v_lshrrev_b32 v41, 16, v44
    v_and_b32 v42, 0xffff, v45
    v_lshrrev_b32 v43, 16, v45
    v_lshl_add_u32 v144, v40, 2, s33
    v_lshl_add_u32 v145, v41, 2, s33
    v_lshl_add_u32 v146, v42, 2, s33
    v_lshl_add_u32 v147, v43, 2, s33
    v_sub_u32 v40, 767, v5
    v_sub_u32 v41, 766, v5
    v_sub_u32 v42, 765, v5
    v_sub_u32 v43, 764, v5
    v_cvt_f32_u32 v40, v40
    v_cvt_f32_u32 v41, v41
    v_cvt_f32_u32 v42, v42
    v_cvt_f32_u32 v43, v43
    v_cvt_pk_bf16_f32 v44, v40, v41
    v_cvt_pk_bf16_f32 v45, v42, v43
    v_and_b32 v40, 0xffff, v44
    v_lshrrev_b32 v41, 16, v44
    v_and_b32 v42, 0xffff, v45
    v_lshrrev_b32 v43, 16, v45
    v_lshl_add_u32 v148, v40, 2, s33
    v_lshl_add_u32 v149, v41, 2, s33
    v_lshl_add_u32 v150, v42, 2, s33
    v_lshl_add_u32 v151, v43, 2, s33
    v_sub_u32 v40, 511, v5
    v_sub_u32 v41, 510, v5
    v_sub_u32 v42, 509, v5
    v_sub_u32 v43, 508, v5
    v_cvt_f32_u32 v40, v40
    v_cvt_f32_u32 v41, v41
    v_cvt_f32_u32 v42, v42
    v_cvt_f32_u32 v43, v43
    v_cvt_pk_bf16_f32 v44, v40, v41
    v_cvt_pk_bf16_f32 v45, v42, v43
    v_and_b32 v40, 0xffff, v44
    v_lshrrev_b32 v41, 16, v44
    v_and_b32 v42, 0xffff, v45
    v_lshrrev_b32 v43, 16, v45
    v_lshl_add_u32 v152, v40, 2, s33
    v_lshl_add_u32 v153, v41, 2, s33
    v_lshl_add_u32 v154, v42, 2, s33
    v_lshl_add_u32 v155, v43, 2, s33
    v_sub_u32 v14, 14576, v6
    v_add_u32 v14, s32, v14
    v_lshrrev_b32 v6, 6, v0
    v_mul_u32_u24 v6, 16384, v6
    v_bfe_u32 v7, v0, 5, 1
    v_mul_u32_u24 v7, 4624, v7
    v_add_u32 v6, v6, v7
    v_and_b32 v7, 31, v0
    v_lshl_add_u32 v6, v7, 4, v6
    v_mov_b32 v8, 0
    v_mov_b32 v9, 0
    v_mov_b32 v10, 0
    v_mov_b32 v11, 0
    ds_write_b128 v6, v[8:11] offset:4224
    v_lshlrev_b32 v7, 4, v1
    v_add_u32 v7, s32, v7
    s_mov_b64 exec, 0xf
    ds_write_b128 v7, v[8:11] offset:4096
    s_mov_b64 exec, -1
    v_lshlrev_b32 v7, 3, v1
    v_add_u32 v7, s32, v7
    s_mov_b32 s34, 0x05040100
    s_mov_b32 s35, 0x07060302
    v_lshlrev_b32 v6, 3, v0
    v_add_u32 v13, 65536, v6
    s_waitcnt vmcnt(0)
    v_perm_b32 v96, v172, v168, s34
    v_perm_b32 v112, v168, v164, s34
    v_perm_b32 v97, v180, v176, s34
    v_perm_b32 v113, v176, v172, s34
    ds_write_b64 v6, v[96:97] offset:4736
    ds_write_b64 v6, v[112:113] offset:9360
    v_perm_b32 v98, v172, v168, s35
    v_perm_b32 v114, v168, v164, s35
    v_perm_b32 v99, v180, v176, s35
    v_perm_b32 v115, v176, v172, s35
    ds_write_b64 v6, v[98:99] offset:21120
    ds_write_b64 v6, v[114:115] offset:25744
    v_perm_b32 v100, v173, v169, s34
    v_perm_b32 v116, v169, v165, s34
    v_perm_b32 v101, v181, v177, s34
    v_perm_b32 v117, v177, v173, s34
    ds_write_b64 v6, v[100:101] offset:37504
    ds_write_b64 v6, v[116:117] offset:42128
    v_perm_b32 v102, v173, v169, s35
    v_perm_b32 v118, v169, v165, s35
    v_perm_b32 v103, v181, v177, s35
    v_perm_b32 v119, v177, v173, s35
    ds_write_b64 v6, v[102:103] offset:53888
    ds_write_b64 v6, v[118:119] offset:58512
    v_perm_b32 v104, v174, v170, s34
    v_perm_b32 v120, v170, v166, s34
    v_perm_b32 v105, v182, v178, s34
    v_perm_b32 v121, v178, v174, s34
    ds_write_b64 v13, v[104:105] offset:4736
    ds_write_b64 v13, v[120:121] offset:9360
    v_perm_b32 v106, v174, v170, s35
    v_perm_b32 v122, v170, v166, s35
    v_perm_b32 v107, v182, v178, s35
    v_perm_b32 v123, v178, v174, s35
    ds_write_b64 v13, v[106:107] offset:21120
    ds_write_b64 v13, v[122:123] offset:25744
    v_perm_b32 v108, v175, v171, s34
    v_perm_b32 v124, v171, v167, s34
    v_perm_b32 v109, v183, v179, s34
    v_perm_b32 v125, v179, v175, s34
    ds_write_b64 v13, v[108:109] offset:37504
    ds_write_b64 v13, v[124:125] offset:42128
    v_perm_b32 v110, v175, v171, s35
    v_perm_b32 v126, v171, v167, s35
    v_perm_b32 v111, v183, v179, s35
    v_perm_b32 v127, v179, v175, s35
    ds_write_b64 v13, v[110:111] offset:53888
    ds_write_b64 v13, v[126:127] offset:58512
    s_waitcnt lgkmcnt(0)
    ds_read_b32 v64, v128
    ds_read_b32 v65, v129
    ds_read_b32 v66, v130
    ds_read_b32 v67, v131
    ds_read_b32 v68, v132
    ds_read_b32 v69, v133
    ds_read_b32 v70, v134
    ds_read_b32 v71, v135
    ds_read_b32 v72, v136
    ds_read_b32 v73, v137
    ds_read_b32 v74, v138
    ds_read_b32 v75, v139
    ds_read_b32 v76, v140
    ds_read_b32 v77, v141
    ds_read_b32 v78, v142
    ds_read_b32 v79, v143
    ds_read_b32 v80, v144
    ds_read_b32 v81, v145
    ds_read_b32 v82, v146
    ds_read_b32 v83, v147
    ds_read_b32 v84, v148
    ds_read_b32 v85, v149
    ds_read_b32 v86, v150
    ds_read_b32 v87, v151
    ds_read_b32 v88, v152
    ds_read_b32 v89, v153
    ds_read_b32 v90, v154
    ds_read_b32 v91, v155
    ds_read_b128 v[92:95], v14
    s_waitcnt lgkmcnt(0)
    v_perm_b32 v40, v65, v64, s34
    v_perm_b32 v41, v67, v66, s34
    ds_write_b64 v7, v[40:41] offset:0
    v_perm_b32 v44, v69, v68, s34
    v_perm_b32 v45, v71, v70, s34
    ds_write_b64 v7, v[44:45] offset:512
    v_perm_b32 v40, v73, v72, s34
    v_perm_b32 v41, v75, v74, s34
    ds_write_b64 v7, v[40:41] offset:1024
    v_perm_b32 v44, v77, v76, s34
    v_perm_b32 v45, v79, v78, s34
    ds_write_b64 v7, v[44:45] offset:1536
    v_perm_b32 v40, v81, v80, s34
    v_perm_b32 v41, v83, v82, s34
    ds_write_b64 v7, v[40:41] offset:2048
    v_perm_b32 v44, v85, v84, s34
    v_perm_b32 v45, v87, v86, s34
    ds_write_b64 v7, v[44:45] offset:2560
    v_perm_b32 v40, v89, v88, s34
    v_perm_b32 v41, v91, v90, s34
    ds_write_b64 v7, v[40:41] offset:3072
    v_perm_b32 v44, v94, v95, s34
    v_perm_b32 v45, v92, v93, s34
    ds_write_b64 v7, v[44:45] offset:3584
    v_and_b32 v8, 15, v1
    v_lshrrev_b32 v9, 4, v1
    v_lshlrev_b32 v10, 2, v8
    v_lshl_add_u32 v10, v9, 4, v10
    v_sub_u32 v10, 3180, v10
    v_add_u32 v44, s32, v10
    v_subrev_u32 v45, 1024, v44
    v_subrev_u32 v46, 2048, v44
    v_subrev_u32 v47, 3072, v44
    v_lshrrev_b32 v11, 1, v8
    v_lshlrev_b32 v11, 6, v11
    v_lshlrev_b32 v12, 4, v9
    v_sub_u32 v11, v11, v12
    v_and_b32 v12, 1, v8
    v_mul_u32_u24 v12, 4624, v12
    v_sub_u32 v11, v11, v12
    v_add_u32 v11, 8960, v11
    v_add_u32 v11, s32, v11
    s_waitcnt lgkmcnt(0)
    s_barrier
    ds_read_b128 v[128:131], v11 offset:448
    ds_read2_b32 v[192:193], v44 offset0:240 offset1:241
    ds_read2_b32 v[194:195], v44 offset0:242 offset1:243
    ds_read_b128 v[132:135], v11 offset:960
    ds_read2_b32 v[196:197], v44 offset0:112 offset1:113
    ds_read2_b32 v[198:199], v44 offset0:114 offset1:115
    ds_read_b128 v[136:139], v11 offset:1472
    ds_read2_b32 v[200:201], v45 offset0:240 offset1:241
    ds_read2_b32 v[202:203], v45 offset0:242 offset1:243
    ds_read_b128 v[140:143], v11 offset:1984
    ds_read2_b32 v[204:205], v45 offset0:112 offset1:113
    ds_read2_b32 v[206:207], v45 offset0:114 offset1:115
    ds_read_b128 v[144:147], v11 offset:2496
    ds_read2_b32 v[208:209], v46 offset0:240 offset1:241
    ds_read2_b32 v[210:211], v46 offset0:242 offset1:243
    ds_read_b128 v[148:151], v11 offset:3008
    ds_read2_b32 v[212:213], v46 offset0:112 offset1:113
    ds_read2_b32 v[214:215], v46 offset0:114 offset1:115
    ds_read_b128 v[152:155], v11 offset:3520
    ds_read2_b32 v[216:217], v47 offset0:240 offset1:241
    ds_read2_b32 v[218:219], v47 offset0:242 offset1:243
    ds_read_b128 v[156:159], v11 offset:4032
    ds_read2_b32 v[220:221], v47 offset0:112 offset1:113
    ds_read2_b32 v[222:223], v47 offset0:114 offset1:115
    s_waitcnt lgkmcnt(0)
    v_mfma_f32_16x16x32_bf16 v[64:67], v[128:131], v[192:195], 0
    ds_read_b128 v[160:163], v11 offset:384
    v_mfma_f32_16x16x32_bf16 v[68:71], v[132:135], v[192:195], 0
    ds_read2_b32 v[224:225], v44 offset0:224 offset1:225
    v_mfma_f32_16x16x32_bf16 v[68:71], v[128:131], v[196:199], v[68:71]
    ds_read2_b32 v[226:227], v44 offset0:226 offset1:227
    v_mfma_f32_16x16x32_bf16 v[72:75], v[136:139], v[192:195], 0
    ds_read_b128 v[164:167], v11 offset:896
    v_mfma_f32_16x16x32_bf16 v[72:75], v[132:135], v[196:199], v[72:75]
    ds_read2_b32 v[228:229], v44 offset0:96 offset1:97
    v_mfma_f32_16x16x32_bf16 v[72:75], v[128:131], v[200:203], v[72:75]
    ds_read2_b32 v[230:231], v44 offset0:98 offset1:99
    v_mfma_f32_16x16x32_bf16 v[76:79], v[140:143], v[192:195], 0
    ds_read_b128 v[168:171], v11 offset:1408
    v_mfma_f32_16x16x32_bf16 v[76:79], v[136:139], v[196:199], v[76:79]
    ds_read2_b32 v[232:233], v45 offset0:224 offset1:225
    v_mfma_f32_16x16x32_bf16 v[76:79], v[132:135], v[200:203], v[76:79]
    ds_read2_b32 v[234:235], v45 offset0:226 offset1:227
    v_mfma_f32_16x16x32_bf16 v[76:79], v[128:131], v[204:207], v[76:79]
    ds_read_b128 v[172:175], v11 offset:1920
    v_mfma_f32_16x16x32_bf16 v[80:83], v[144:147], v[192:195], 0
    ds_read2_b32 v[236:237], v45 offset0:96 offset1:97
    v_mfma_f32_16x16x32_bf16 v[80:83], v[140:143], v[196:199], v[80:83]
    ds_read2_b32 v[238:239], v45 offset0:98 offset1:99
    v_mfma_f32_16x16x32_bf16 v[80:83], v[136:139], v[200:203], v[80:83]
    ds_read_b128 v[176:179], v11 offset:2432
    v_mfma_f32_16x16x32_bf16 v[80:83], v[132:135], v[204:207], v[80:83]
    ds_read2_b32 v[240:241], v46 offset0:224 offset1:225
    v_mfma_f32_16x16x32_bf16 v[80:83], v[128:131], v[208:211], v[80:83]
    ds_read2_b32 v[242:243], v46 offset0:226 offset1:227
    v_mfma_f32_16x16x32_bf16 v[84:87], v[148:151], v[192:195], 0
    ds_read_b128 v[180:183], v11 offset:2944
    v_mfma_f32_16x16x32_bf16 v[84:87], v[144:147], v[196:199], v[84:87]
    ds_read2_b32 v[244:245], v46 offset0:96 offset1:97
    v_mfma_f32_16x16x32_bf16 v[84:87], v[140:143], v[200:203], v[84:87]
    ds_read2_b32 v[246:247], v46 offset0:98 offset1:99
    v_mfma_f32_16x16x32_bf16 v[84:87], v[136:139], v[204:207], v[84:87]
    ds_read_b128 v[184:187], v11 offset:3456
    v_mfma_f32_16x16x32_bf16 v[84:87], v[132:135], v[208:211], v[84:87]
    ds_read2_b32 v[248:249], v47 offset0:224 offset1:225
    v_mfma_f32_16x16x32_bf16 v[84:87], v[128:131], v[212:215], v[84:87]
    ds_read2_b32 v[250:251], v47 offset0:226 offset1:227
    v_mfma_f32_16x16x32_bf16 v[88:91], v[152:155], v[192:195], 0
    ds_read_b128 v[188:191], v11 offset:3968
    v_mfma_f32_16x16x32_bf16 v[88:91], v[148:151], v[196:199], v[88:91]
    ds_read2_b32 v[252:253], v47 offset0:96 offset1:97
    v_mfma_f32_16x16x32_bf16 v[88:91], v[144:147], v[200:203], v[88:91]
    ds_read2_b32 v[254:255], v47 offset0:98 offset1:99
    v_mfma_f32_16x16x32_bf16 v[88:91], v[140:143], v[204:207], v[88:91]
    v_mfma_f32_16x16x32_bf16 v[88:91], v[136:139], v[208:211], v[88:91]
    v_mfma_f32_16x16x32_bf16 v[88:91], v[132:135], v[212:215], v[88:91]
    v_mfma_f32_16x16x32_bf16 v[88:91], v[128:131], v[216:219], v[88:91]
    v_mfma_f32_16x16x32_bf16 v[92:95], v[156:159], v[192:195], 0
    v_mfma_f32_16x16x32_bf16 v[92:95], v[152:155], v[196:199], v[92:95]
    v_mfma_f32_16x16x32_bf16 v[92:95], v[148:151], v[200:203], v[92:95]
    v_mfma_f32_16x16x32_bf16 v[92:95], v[144:147], v[204:207], v[92:95]
    v_mfma_f32_16x16x32_bf16 v[92:95], v[140:143], v[208:211], v[92:95]
    v_mfma_f32_16x16x32_bf16 v[92:95], v[136:139], v[212:215], v[92:95]
    v_mfma_f32_16x16x32_bf16 v[92:95], v[132:135], v[216:219], v[92:95]
    v_mfma_f32_16x16x32_bf16 v[92:95], v[128:131], v[220:223], v[92:95]
    s_waitcnt lgkmcnt(0)
    v_mfma_f32_16x16x32_bf16 v[64:67], v[160:163], v[224:227], v[64:67]
    ds_read_b128 v[128:131], v11 offset:320
    v_mfma_f32_16x16x32_bf16 v[68:71], v[164:167], v[224:227], v[68:71]
    ds_read2_b32 v[192:193], v44 offset0:208 offset1:209
    v_mfma_f32_16x16x32_bf16 v[68:71], v[160:163], v[228:231], v[68:71]
    ds_read2_b32 v[194:195], v44 offset0:210 offset1:211
    v_mfma_f32_16x16x32_bf16 v[72:75], v[168:171], v[224:227], v[72:75]
    ds_read_b128 v[132:135], v11 offset:832
    v_mfma_f32_16x16x32_bf16 v[72:75], v[164:167], v[228:231], v[72:75]
    ds_read2_b32 v[196:197], v44 offset0:80 offset1:81
    v_mfma_f32_16x16x32_bf16 v[72:75], v[160:163], v[232:235], v[72:75]
    ds_read2_b32 v[198:199], v44 offset0:82 offset1:83
    v_mfma_f32_16x16x32_bf16 v[76:79], v[172:175], v[224:227], v[76:79]
    ds_read_b128 v[136:139], v11 offset:1344
    v_mfma_f32_16x16x32_bf16 v[76:79], v[168:171], v[228:231], v[76:79]
    ds_read2_b32 v[200:201], v45 offset0:208 offset1:209
    v_mfma_f32_16x16x32_bf16 v[76:79], v[164:167], v[232:235], v[76:79]
    ds_read2_b32 v[202:203], v45 offset0:210 offset1:211
    v_mfma_f32_16x16x32_bf16 v[76:79], v[160:163], v[236:239], v[76:79]
    ds_read_b128 v[140:143], v11 offset:1856
    v_mfma_f32_16x16x32_bf16 v[80:83], v[176:179], v[224:227], v[80:83]
    ds_read2_b32 v[204:205], v45 offset0:80 offset1:81
    v_mfma_f32_16x16x32_bf16 v[80:83], v[172:175], v[228:231], v[80:83]
    ds_read2_b32 v[206:207], v45 offset0:82 offset1:83
    v_mfma_f32_16x16x32_bf16 v[80:83], v[168:171], v[232:235], v[80:83]
    ds_read_b128 v[144:147], v11 offset:2368
    v_mfma_f32_16x16x32_bf16 v[80:83], v[164:167], v[236:239], v[80:83]
    ds_read2_b32 v[208:209], v46 offset0:208 offset1:209
    v_mfma_f32_16x16x32_bf16 v[80:83], v[160:163], v[240:243], v[80:83]
    ds_read2_b32 v[210:211], v46 offset0:210 offset1:211
    v_mfma_f32_16x16x32_bf16 v[84:87], v[180:183], v[224:227], v[84:87]
    ds_read_b128 v[148:151], v11 offset:2880
    v_mfma_f32_16x16x32_bf16 v[84:87], v[176:179], v[228:231], v[84:87]
    ds_read2_b32 v[212:213], v46 offset0:80 offset1:81
    v_mfma_f32_16x16x32_bf16 v[84:87], v[172:175], v[232:235], v[84:87]
    ds_read2_b32 v[214:215], v46 offset0:82 offset1:83
    v_mfma_f32_16x16x32_bf16 v[84:87], v[168:171], v[236:239], v[84:87]
    ds_read_b128 v[152:155], v11 offset:3392
    v_mfma_f32_16x16x32_bf16 v[84:87], v[164:167], v[240:243], v[84:87]
    ds_read2_b32 v[216:217], v47 offset0:208 offset1:209
    v_mfma_f32_16x16x32_bf16 v[84:87], v[160:163], v[244:247], v[84:87]
    ds_read2_b32 v[218:219], v47 offset0:210 offset1:211
    v_mfma_f32_16x16x32_bf16 v[88:91], v[184:187], v[224:227], v[88:91]
    ds_read_b128 v[156:159], v11 offset:3904
    v_mfma_f32_16x16x32_bf16 v[88:91], v[180:183], v[228:231], v[88:91]
    ds_read2_b32 v[220:221], v47 offset0:80 offset1:81
    v_mfma_f32_16x16x32_bf16 v[88:91], v[176:179], v[232:235], v[88:91]
    ds_read2_b32 v[222:223], v47 offset0:82 offset1:83
    v_mfma_f32_16x16x32_bf16 v[88:91], v[172:175], v[236:239], v[88:91]
    v_mfma_f32_16x16x32_bf16 v[88:91], v[168:171], v[240:243], v[88:91]
    v_mfma_f32_16x16x32_bf16 v[88:91], v[164:167], v[244:247], v[88:91]
    v_mfma_f32_16x16x32_bf16 v[88:91], v[160:163], v[248:251], v[88:91]
    v_mfma_f32_16x16x32_bf16 v[92:95], v[188:191], v[224:227], v[92:95]
    v_mfma_f32_16x16x32_bf16 v[92:95], v[184:187], v[228:231], v[92:95]
    v_mfma_f32_16x16x32_bf16 v[92:95], v[180:183], v[232:235], v[92:95]
    v_mfma_f32_16x16x32_bf16 v[92:95], v[176:179], v[236:239], v[92:95]
    v_mfma_f32_16x16x32_bf16 v[92:95], v[172:175], v[240:243], v[92:95]
    v_mfma_f32_16x16x32_bf16 v[92:95], v[168:171], v[244:247], v[92:95]
    v_mfma_f32_16x16x32_bf16 v[92:95], v[164:167], v[248:251], v[92:95]
    v_mfma_f32_16x16x32_bf16 v[92:95], v[160:163], v[252:255], v[92:95]
    s_waitcnt lgkmcnt(0)
    v_mfma_f32_16x16x32_bf16 v[64:67], v[128:131], v[192:195], v[64:67]
    ds_read_b128 v[160:163], v11 offset:256
    v_mfma_f32_16x16x32_bf16 v[68:71], v[132:135], v[192:195], v[68:71]
    ds_read2_b32 v[224:225], v44 offset0:192 offset1:193
    v_mfma_f32_16x16x32_bf16 v[68:71], v[128:131], v[196:199], v[68:71]
    ds_read2_b32 v[226:227], v44 offset0:194 offset1:195
    v_mfma_f32_16x16x32_bf16 v[72:75], v[136:139], v[192:195], v[72:75]
    ds_read_b128 v[164:167], v11 offset:768
    v_mfma_f32_16x16x32_bf16 v[72:75], v[132:135], v[196:199], v[72:75]
    ds_read2_b32 v[228:229], v44 offset0:64 offset1:65
    v_mfma_f32_16x16x32_bf16 v[72:75], v[128:131], v[200:203], v[72:75]
    ds_read2_b32 v[230:231], v44 offset0:66 offset1:67
    v_mfma_f32_16x16x32_bf16 v[76:79], v[140:143], v[192:195], v[76:79]
    ds_read_b128 v[168:171], v11 offset:1280
    v_mfma_f32_16x16x32_bf16 v[76:79], v[136:139], v[196:199], v[76:79]
    ds_read2_b32 v[232:233], v45 offset0:192 offset1:193
    v_mfma_f32_16x16x32_bf16 v[76:79], v[132:135], v[200:203], v[76:79]
    ds_read2_b32 v[234:235], v45 offset0:194 offset1:195
    v_mfma_f32_16x16x32_bf16 v[76:79], v[128:131], v[204:207], v[76:79]
    ds_read_b128 v[172:175], v11 offset:1792
    v_mfma_f32_16x16x32_bf16 v[80:83], v[144:147], v[192:195], v[80:83]
    ds_read2_b32 v[236:237], v45 offset0:64 offset1:65
    v_mfma_f32_16x16x32_bf16 v[80:83], v[140:143], v[196:199], v[80:83]
    ds_read2_b32 v[238:239], v45 offset0:66 offset1:67
    v_mfma_f32_16x16x32_bf16 v[80:83], v[136:139], v[200:203], v[80:83]
    ds_read_b128 v[176:179], v11 offset:2304
    v_mfma_f32_16x16x32_bf16 v[80:83], v[132:135], v[204:207], v[80:83]
    ds_read2_b32 v[240:241], v46 offset0:192 offset1:193
    v_mfma_f32_16x16x32_bf16 v[80:83], v[128:131], v[208:211], v[80:83]
    ds_read2_b32 v[242:243], v46 offset0:194 offset1:195
    v_mfma_f32_16x16x32_bf16 v[84:87], v[148:151], v[192:195], v[84:87]
    ds_read_b128 v[180:183], v11 offset:2816
    v_mfma_f32_16x16x32_bf16 v[84:87], v[144:147], v[196:199], v[84:87]
    ds_read2_b32 v[244:245], v46 offset0:64 offset1:65
    v_mfma_f32_16x16x32_bf16 v[84:87], v[140:143], v[200:203], v[84:87]
    ds_read2_b32 v[246:247], v46 offset0:66 offset1:67
    v_mfma_f32_16x16x32_bf16 v[84:87], v[136:139], v[204:207], v[84:87]
    ds_read_b128 v[184:187], v11 offset:3328
    v_mfma_f32_16x16x32_bf16 v[84:87], v[132:135], v[208:211], v[84:87]
    ds_read2_b32 v[248:249], v47 offset0:192 offset1:193
    v_mfma_f32_16x16x32_bf16 v[84:87], v[128:131], v[212:215], v[84:87]
    ds_read2_b32 v[250:251], v47 offset0:194 offset1:195
    v_mfma_f32_16x16x32_bf16 v[88:91], v[152:155], v[192:195], v[88:91]
    ds_read_b128 v[188:191], v11 offset:3840
    v_mfma_f32_16x16x32_bf16 v[88:91], v[148:151], v[196:199], v[88:91]
    ds_read2_b32 v[252:253], v47 offset0:64 offset1:65
    v_mfma_f32_16x16x32_bf16 v[88:91], v[144:147], v[200:203], v[88:91]
    ds_read2_b32 v[254:255], v47 offset0:66 offset1:67
    v_mfma_f32_16x16x32_bf16 v[88:91], v[140:143], v[204:207], v[88:91]
    v_mfma_f32_16x16x32_bf16 v[88:91], v[136:139], v[208:211], v[88:91]
    v_mfma_f32_16x16x32_bf16 v[88:91], v[132:135], v[212:215], v[88:91]
    v_mfma_f32_16x16x32_bf16 v[88:91], v[128:131], v[216:219], v[88:91]
    v_mfma_f32_16x16x32_bf16 v[92:95], v[156:159], v[192:195], v[92:95]
    v_mfma_f32_16x16x32_bf16 v[92:95], v[152:155], v[196:199], v[92:95]
    v_mfma_f32_16x16x32_bf16 v[92:95], v[148:151], v[200:203], v[92:95]
    v_mfma_f32_16x16x32_bf16 v[92:95], v[144:147], v[204:207], v[92:95]
    v_mfma_f32_16x16x32_bf16 v[92:95], v[140:143], v[208:211], v[92:95]
    v_mfma_f32_16x16x32_bf16 v[92:95], v[136:139], v[212:215], v[92:95]
    v_mfma_f32_16x16x32_bf16 v[92:95], v[132:135], v[216:219], v[92:95]
    v_mfma_f32_16x16x32_bf16 v[92:95], v[128:131], v[220:223], v[92:95]
    s_waitcnt lgkmcnt(0)
    v_mfma_f32_16x16x32_bf16 v[64:67], v[160:163], v[224:227], v[64:67]
    ds_read_b128 v[128:131], v11 offset:192
    v_mfma_f32_16x16x32_bf16 v[68:71], v[164:167], v[224:227], v[68:71]
    ds_read2_b32 v[192:193], v44 offset0:176 offset1:177
    v_mfma_f32_16x16x32_bf16 v[68:71], v[160:163], v[228:231], v[68:71]
    ds_read2_b32 v[194:195], v44 offset0:178 offset1:179
    v_mfma_f32_16x16x32_bf16 v[72:75], v[168:171], v[224:227], v[72:75]
    ds_read_b128 v[132:135], v11 offset:704
    v_mfma_f32_16x16x32_bf16 v[72:75], v[164:167], v[228:231], v[72:75]
    ds_read2_b32 v[196:197], v44 offset0:48 offset1:49
    v_mfma_f32_16x16x32_bf16 v[72:75], v[160:163], v[232:235], v[72:75]
    ds_read2_b32 v[198:199], v44 offset0:50 offset1:51
    v_mfma_f32_16x16x32_bf16 v[76:79], v[172:175], v[224:227], v[76:79]
    ds_read_b128 v[136:139], v11 offset:1216
    v_mfma_f32_16x16x32_bf16 v[76:79], v[168:171], v[228:231], v[76:79]
    ds_read2_b32 v[200:201], v45 offset0:176 offset1:177
    v_mfma_f32_16x16x32_bf16 v[76:79], v[164:167], v[232:235], v[76:79]
    ds_read2_b32 v[202:203], v45 offset0:178 offset1:179
    v_mfma_f32_16x16x32_bf16 v[76:79], v[160:163], v[236:239], v[76:79]
    ds_read_b128 v[140:143], v11 offset:1728
    v_mfma_f32_16x16x32_bf16 v[80:83], v[176:179], v[224:227], v[80:83]
    ds_read2_b32 v[204:205], v45 offset0:48 offset1:49
    v_mfma_f32_16x16x32_bf16 v[80:83], v[172:175], v[228:231], v[80:83]
    ds_read2_b32 v[206:207], v45 offset0:50 offset1:51
    v_mfma_f32_16x16x32_bf16 v[80:83], v[168:171], v[232:235], v[80:83]
    ds_read_b128 v[144:147], v11 offset:2240
    v_mfma_f32_16x16x32_bf16 v[80:83], v[164:167], v[236:239], v[80:83]
    ds_read2_b32 v[208:209], v46 offset0:176 offset1:177
    v_mfma_f32_16x16x32_bf16 v[80:83], v[160:163], v[240:243], v[80:83]
    ds_read2_b32 v[210:211], v46 offset0:178 offset1:179
    v_mfma_f32_16x16x32_bf16 v[84:87], v[180:183], v[224:227], v[84:87]
    ds_read_b128 v[148:151], v11 offset:2752
    v_mfma_f32_16x16x32_bf16 v[84:87], v[176:179], v[228:231], v[84:87]
    ds_read2_b32 v[212:213], v46 offset0:48 offset1:49
    v_mfma_f32_16x16x32_bf16 v[84:87], v[172:175], v[232:235], v[84:87]
    ds_read2_b32 v[214:215], v46 offset0:50 offset1:51
    v_mfma_f32_16x16x32_bf16 v[84:87], v[168:171], v[236:239], v[84:87]
    ds_read_b128 v[152:155], v11 offset:3264
    v_mfma_f32_16x16x32_bf16 v[84:87], v[164:167], v[240:243], v[84:87]
    ds_read2_b32 v[216:217], v47 offset0:176 offset1:177
    v_mfma_f32_16x16x32_bf16 v[84:87], v[160:163], v[244:247], v[84:87]
    ds_read2_b32 v[218:219], v47 offset0:178 offset1:179
    v_mfma_f32_16x16x32_bf16 v[88:91], v[184:187], v[224:227], v[88:91]
    ds_read_b128 v[156:159], v11 offset:3776
    v_mfma_f32_16x16x32_bf16 v[88:91], v[180:183], v[228:231], v[88:91]
    ds_read2_b32 v[220:221], v47 offset0:48 offset1:49
    v_mfma_f32_16x16x32_bf16 v[88:91], v[176:179], v[232:235], v[88:91]
    ds_read2_b32 v[222:223], v47 offset0:50 offset1:51
    v_mfma_f32_16x16x32_bf16 v[88:91], v[172:175], v[236:239], v[88:91]
    v_mfma_f32_16x16x32_bf16 v[88:91], v[168:171], v[240:243], v[88:91]
    v_mfma_f32_16x16x32_bf16 v[88:91], v[164:167], v[244:247], v[88:91]
    v_mfma_f32_16x16x32_bf16 v[88:91], v[160:163], v[248:251], v[88:91]
    v_mfma_f32_16x16x32_bf16 v[92:95], v[188:191], v[224:227], v[92:95]
    v_mfma_f32_16x16x32_bf16 v[92:95], v[184:187], v[228:231], v[92:95]
    v_mfma_f32_16x16x32_bf16 v[92:95], v[180:183], v[232:235], v[92:95]
    v_mfma_f32_16x16x32_bf16 v[92:95], v[176:179], v[236:239], v[92:95]
    v_mfma_f32_16x16x32_bf16 v[92:95], v[172:175], v[240:243], v[92:95]
    v_mfma_f32_16x16x32_bf16 v[92:95], v[168:171], v[244:247], v[92:95]
    v_mfma_f32_16x16x32_bf16 v[92:95], v[164:167], v[248:251], v[92:95]
    v_mfma_f32_16x16x32_bf16 v[92:95], v[160:163], v[252:255], v[92:95]
    s_waitcnt lgkmcnt(0)
    v_mfma_f32_16x16x32_bf16 v[64:67], v[128:131], v[192:195], v[64:67]
    ds_read_b128 v[160:163], v11 offset:128
    v_mfma_f32_16x16x32_bf16 v[68:71], v[132:135], v[192:195], v[68:71]
    ds_read2_b32 v[224:225], v44 offset0:160 offset1:161
    v_mfma_f32_16x16x32_bf16 v[68:71], v[128:131], v[196:199], v[68:71]
    ds_read2_b32 v[226:227], v44 offset0:162 offset1:163
    v_mfma_f32_16x16x32_bf16 v[72:75], v[136:139], v[192:195], v[72:75]
    ds_read_b128 v[164:167], v11 offset:640
    v_mfma_f32_16x16x32_bf16 v[72:75], v[132:135], v[196:199], v[72:75]
    ds_read2_b32 v[228:229], v44 offset0:32 offset1:33
    v_mfma_f32_16x16x32_bf16 v[72:75], v[128:131], v[200:203], v[72:75]
    ds_read2_b32 v[230:231], v44 offset0:34 offset1:35
    v_mfma_f32_16x16x32_bf16 v[76:79], v[140:143], v[192:195], v[76:79]
    ds_read_b128 v[168:171], v11 offset:1152
    v_mfma_f32_16x16x32_bf16 v[76:79], v[136:139], v[196:199], v[76:79]
    ds_read2_b32 v[232:233], v45 offset0:160 offset1:161
    v_mfma_f32_16x16x32_bf16 v[76:79], v[132:135], v[200:203], v[76:79]
    ds_read2_b32 v[234:235], v45 offset0:162 offset1:163
    v_mfma_f32_16x16x32_bf16 v[76:79], v[128:131], v[204:207], v[76:79]
    ds_read_b128 v[172:175], v11 offset:1664
    v_mfma_f32_16x16x32_bf16 v[80:83], v[144:147], v[192:195], v[80:83]
    ds_read2_b32 v[236:237], v45 offset0:32 offset1:33
    v_mfma_f32_16x16x32_bf16 v[80:83], v[140:143], v[196:199], v[80:83]
    ds_read2_b32 v[238:239], v45 offset0:34 offset1:35
    v_mfma_f32_16x16x32_bf16 v[80:83], v[136:139], v[200:203], v[80:83]
    ds_read_b128 v[176:179], v11 offset:2176
    v_mfma_f32_16x16x32_bf16 v[80:83], v[132:135], v[204:207], v[80:83]
    ds_read2_b32 v[240:241], v46 offset0:160 offset1:161
    v_mfma_f32_16x16x32_bf16 v[80:83], v[128:131], v[208:211], v[80:83]
    ds_read2_b32 v[242:243], v46 offset0:162 offset1:163
    v_mfma_f32_16x16x32_bf16 v[84:87], v[148:151], v[192:195], v[84:87]
    ds_read_b128 v[180:183], v11 offset:2688
    v_mfma_f32_16x16x32_bf16 v[84:87], v[144:147], v[196:199], v[84:87]
    ds_read2_b32 v[244:245], v46 offset0:32 offset1:33
    v_mfma_f32_16x16x32_bf16 v[84:87], v[140:143], v[200:203], v[84:87]
    ds_read2_b32 v[246:247], v46 offset0:34 offset1:35
    v_mfma_f32_16x16x32_bf16 v[84:87], v[136:139], v[204:207], v[84:87]
    ds_read_b128 v[184:187], v11 offset:3200
    v_mfma_f32_16x16x32_bf16 v[84:87], v[132:135], v[208:211], v[84:87]
    ds_read2_b32 v[248:249], v47 offset0:160 offset1:161
    v_mfma_f32_16x16x32_bf16 v[84:87], v[128:131], v[212:215], v[84:87]
    ds_read2_b32 v[250:251], v47 offset0:162 offset1:163
    v_mfma_f32_16x16x32_bf16 v[88:91], v[152:155], v[192:195], v[88:91]
    ds_read_b128 v[188:191], v11 offset:3712
    v_mfma_f32_16x16x32_bf16 v[88:91], v[148:151], v[196:199], v[88:91]
    ds_read2_b32 v[252:253], v47 offset0:32 offset1:33
    v_mfma_f32_16x16x32_bf16 v[88:91], v[144:147], v[200:203], v[88:91]
    ds_read2_b32 v[254:255], v47 offset0:34 offset1:35
    v_mfma_f32_16x16x32_bf16 v[88:91], v[140:143], v[204:207], v[88:91]
    v_mfma_f32_16x16x32_bf16 v[88:91], v[136:139], v[208:211], v[88:91]
    v_mfma_f32_16x16x32_bf16 v[88:91], v[132:135], v[212:215], v[88:91]
    v_mfma_f32_16x16x32_bf16 v[88:91], v[128:131], v[216:219], v[88:91]
    v_mfma_f32_16x16x32_bf16 v[92:95], v[156:159], v[192:195], v[92:95]
    v_mfma_f32_16x16x32_bf16 v[92:95], v[152:155], v[196:199], v[92:95]
    v_mfma_f32_16x16x32_bf16 v[92:95], v[148:151], v[200:203], v[92:95]
    v_mfma_f32_16x16x32_bf16 v[92:95], v[144:147], v[204:207], v[92:95]
    v_mfma_f32_16x16x32_bf16 v[92:95], v[140:143], v[208:211], v[92:95]
    v_mfma_f32_16x16x32_bf16 v[92:95], v[136:139], v[212:215], v[92:95]
    v_mfma_f32_16x16x32_bf16 v[92:95], v[132:135], v[216:219], v[92:95]
    v_mfma_f32_16x16x32_bf16 v[92:95], v[128:131], v[220:223], v[92:95]
    s_waitcnt lgkmcnt(0)
    v_mfma_f32_16x16x32_bf16 v[64:67], v[160:163], v[224:227], v[64:67]
    ds_read_b128 v[128:131], v11 offset:64
    v_mfma_f32_16x16x32_bf16 v[68:71], v[164:167], v[224:227], v[68:71]
    ds_read2_b32 v[192:193], v44 offset0:144 offset1:145
    v_mfma_f32_16x16x32_bf16 v[68:71], v[160:163], v[228:231], v[68:71]
    ds_read2_b32 v[194:195], v44 offset0:146 offset1:147
    v_mfma_f32_16x16x32_bf16 v[72:75], v[168:171], v[224:227], v[72:75]
    ds_read_b128 v[132:135], v11 offset:576
    v_mfma_f32_16x16x32_bf16 v[72:75], v[164:167], v[228:231], v[72:75]
    ds_read2_b32 v[196:197], v44 offset0:16 offset1:17
    v_mfma_f32_16x16x32_bf16 v[72:75], v[160:163], v[232:235], v[72:75]
    ds_read2_b32 v[198:199], v44 offset0:18 offset1:19
    v_mfma_f32_16x16x32_bf16 v[76:79], v[172:175], v[224:227], v[76:79]
    ds_read_b128 v[136:139], v11 offset:1088
    v_mfma_f32_16x16x32_bf16 v[76:79], v[168:171], v[228:231], v[76:79]
    ds_read2_b32 v[200:201], v45 offset0:144 offset1:145
    v_mfma_f32_16x16x32_bf16 v[76:79], v[164:167], v[232:235], v[76:79]
    ds_read2_b32 v[202:203], v45 offset0:146 offset1:147
    v_mfma_f32_16x16x32_bf16 v[76:79], v[160:163], v[236:239], v[76:79]
    ds_read_b128 v[140:143], v11 offset:1600
    v_mfma_f32_16x16x32_bf16 v[80:83], v[176:179], v[224:227], v[80:83]
    ds_read2_b32 v[204:205], v45 offset0:16 offset1:17
    v_mfma_f32_16x16x32_bf16 v[80:83], v[172:175], v[228:231], v[80:83]
    ds_read2_b32 v[206:207], v45 offset0:18 offset1:19
    v_mfma_f32_16x16x32_bf16 v[80:83], v[168:171], v[232:235], v[80:83]
    ds_read_b128 v[144:147], v11 offset:2112
    v_mfma_f32_16x16x32_bf16 v[80:83], v[164:167], v[236:239], v[80:83]
    ds_read2_b32 v[208:209], v46 offset0:144 offset1:145
    v_mfma_f32_16x16x32_bf16 v[80:83], v[160:163], v[240:243], v[80:83]
    ds_read2_b32 v[210:211], v46 offset0:146 offset1:147
    v_mfma_f32_16x16x32_bf16 v[84:87], v[180:183], v[224:227], v[84:87]
    ds_read_b128 v[148:151], v11 offset:2624
    v_mfma_f32_16x16x32_bf16 v[84:87], v[176:179], v[228:231], v[84:87]
    ds_read2_b32 v[212:213], v46 offset0:16 offset1:17
    v_mfma_f32_16x16x32_bf16 v[84:87], v[172:175], v[232:235], v[84:87]
    ds_read2_b32 v[214:215], v46 offset0:18 offset1:19
    v_mfma_f32_16x16x32_bf16 v[84:87], v[168:171], v[236:239], v[84:87]
    ds_read_b128 v[152:155], v11 offset:3136
    v_mfma_f32_16x16x32_bf16 v[84:87], v[164:167], v[240:243], v[84:87]
    ds_read2_b32 v[216:217], v47 offset0:144 offset1:145
    v_mfma_f32_16x16x32_bf16 v[84:87], v[160:163], v[244:247], v[84:87]
    ds_read2_b32 v[218:219], v47 offset0:146 offset1:147
    v_mfma_f32_16x16x32_bf16 v[88:91], v[184:187], v[224:227], v[88:91]
    ds_read_b128 v[156:159], v11 offset:3648
    v_mfma_f32_16x16x32_bf16 v[88:91], v[180:183], v[228:231], v[88:91]
    ds_read2_b32 v[220:221], v47 offset0:16 offset1:17
    v_mfma_f32_16x16x32_bf16 v[88:91], v[176:179], v[232:235], v[88:91]
    ds_read2_b32 v[222:223], v47 offset0:18 offset1:19
    v_mfma_f32_16x16x32_bf16 v[88:91], v[172:175], v[236:239], v[88:91]
    v_mfma_f32_16x16x32_bf16 v[88:91], v[168:171], v[240:243], v[88:91]
    v_mfma_f32_16x16x32_bf16 v[88:91], v[164:167], v[244:247], v[88:91]
    v_mfma_f32_16x16x32_bf16 v[88:91], v[160:163], v[248:251], v[88:91]
    v_mfma_f32_16x16x32_bf16 v[92:95], v[188:191], v[224:227], v[92:95]
    v_mfma_f32_16x16x32_bf16 v[92:95], v[184:187], v[228:231], v[92:95]
    v_mfma_f32_16x16x32_bf16 v[92:95], v[180:183], v[232:235], v[92:95]
    v_mfma_f32_16x16x32_bf16 v[92:95], v[176:179], v[236:239], v[92:95]
    v_mfma_f32_16x16x32_bf16 v[92:95], v[172:175], v[240:243], v[92:95]
    v_mfma_f32_16x16x32_bf16 v[92:95], v[168:171], v[244:247], v[92:95]
    v_mfma_f32_16x16x32_bf16 v[92:95], v[164:167], v[248:251], v[92:95]
    v_mfma_f32_16x16x32_bf16 v[92:95], v[160:163], v[252:255], v[92:95]
    s_waitcnt lgkmcnt(0)
    v_mfma_f32_16x16x32_bf16 v[64:67], v[128:131], v[192:195], v[64:67]
    ds_read_b128 v[160:163], v11 offset:0
    v_mfma_f32_16x16x32_bf16 v[68:71], v[132:135], v[192:195], v[68:71]
    ds_read2_b32 v[224:225], v44 offset0:128 offset1:129
    v_mfma_f32_16x16x32_bf16 v[68:71], v[128:131], v[196:199], v[68:71]
    ds_read2_b32 v[226:227], v44 offset0:130 offset1:131
    v_mfma_f32_16x16x32_bf16 v[72:75], v[136:139], v[192:195], v[72:75]
    ds_read_b128 v[164:167], v11 offset:512
    v_mfma_f32_16x16x32_bf16 v[72:75], v[132:135], v[196:199], v[72:75]
    ds_read2_b32 v[228:229], v44 offset0:0 offset1:1
    v_mfma_f32_16x16x32_bf16 v[72:75], v[128:131], v[200:203], v[72:75]
    ds_read2_b32 v[230:231], v44 offset0:2 offset1:3
    v_mfma_f32_16x16x32_bf16 v[76:79], v[140:143], v[192:195], v[76:79]
    ds_read_b128 v[168:171], v11 offset:1024
    v_mfma_f32_16x16x32_bf16 v[76:79], v[136:139], v[196:199], v[76:79]
    ds_read2_b32 v[232:233], v45 offset0:128 offset1:129
    v_mfma_f32_16x16x32_bf16 v[76:79], v[132:135], v[200:203], v[76:79]
    ds_read2_b32 v[234:235], v45 offset0:130 offset1:131
    v_mfma_f32_16x16x32_bf16 v[76:79], v[128:131], v[204:207], v[76:79]
    ds_read_b128 v[172:175], v11 offset:1536
    v_mfma_f32_16x16x32_bf16 v[80:83], v[144:147], v[192:195], v[80:83]
    ds_read2_b32 v[236:237], v45 offset0:0 offset1:1
    v_mfma_f32_16x16x32_bf16 v[80:83], v[140:143], v[196:199], v[80:83]
    ds_read2_b32 v[238:239], v45 offset0:2 offset1:3
    v_mfma_f32_16x16x32_bf16 v[80:83], v[136:139], v[200:203], v[80:83]
    ds_read_b128 v[176:179], v11 offset:2048
    v_mfma_f32_16x16x32_bf16 v[80:83], v[132:135], v[204:207], v[80:83]
    ds_read2_b32 v[240:241], v46 offset0:128 offset1:129
    v_mfma_f32_16x16x32_bf16 v[80:83], v[128:131], v[208:211], v[80:83]
    ds_read2_b32 v[242:243], v46 offset0:130 offset1:131
    v_mfma_f32_16x16x32_bf16 v[84:87], v[148:151], v[192:195], v[84:87]
    ds_read_b128 v[180:183], v11 offset:2560
    v_mfma_f32_16x16x32_bf16 v[84:87], v[144:147], v[196:199], v[84:87]
    ds_read2_b32 v[244:245], v46 offset0:0 offset1:1
    v_mfma_f32_16x16x32_bf16 v[84:87], v[140:143], v[200:203], v[84:87]
    ds_read2_b32 v[246:247], v46 offset0:2 offset1:3
    v_mfma_f32_16x16x32_bf16 v[84:87], v[136:139], v[204:207], v[84:87]
    ds_read_b128 v[184:187], v11 offset:3072
    v_mfma_f32_16x16x32_bf16 v[84:87], v[132:135], v[208:211], v[84:87]
    ds_read2_b32 v[248:249], v47 offset0:128 offset1:129
    v_mfma_f32_16x16x32_bf16 v[84:87], v[128:131], v[212:215], v[84:87]
    ds_read2_b32 v[250:251], v47 offset0:130 offset1:131
    v_mfma_f32_16x16x32_bf16 v[88:91], v[152:155], v[192:195], v[88:91]
    ds_read_b128 v[188:191], v11 offset:3584
    v_mfma_f32_16x16x32_bf16 v[88:91], v[148:151], v[196:199], v[88:91]
    ds_read2_b32 v[252:253], v47 offset0:0 offset1:1
    v_mfma_f32_16x16x32_bf16 v[88:91], v[144:147], v[200:203], v[88:91]
    ds_read2_b32 v[254:255], v47 offset0:2 offset1:3
    v_mfma_f32_16x16x32_bf16 v[88:91], v[140:143], v[204:207], v[88:91]
    v_mfma_f32_16x16x32_bf16 v[88:91], v[136:139], v[208:211], v[88:91]
    v_mfma_f32_16x16x32_bf16 v[88:91], v[132:135], v[212:215], v[88:91]
    v_mfma_f32_16x16x32_bf16 v[88:91], v[128:131], v[216:219], v[88:91]
    v_mfma_f32_16x16x32_bf16 v[92:95], v[156:159], v[192:195], v[92:95]
    v_mfma_f32_16x16x32_bf16 v[92:95], v[152:155], v[196:199], v[92:95]
    v_mfma_f32_16x16x32_bf16 v[92:95], v[148:151], v[200:203], v[92:95]
    v_mfma_f32_16x16x32_bf16 v[92:95], v[144:147], v[204:207], v[92:95]
    v_mfma_f32_16x16x32_bf16 v[92:95], v[140:143], v[208:211], v[92:95]
    v_mfma_f32_16x16x32_bf16 v[92:95], v[136:139], v[212:215], v[92:95]
    v_mfma_f32_16x16x32_bf16 v[92:95], v[132:135], v[216:219], v[92:95]
    v_mfma_f32_16x16x32_bf16 v[92:95], v[128:131], v[220:223], v[92:95]
    s_waitcnt lgkmcnt(0)
    v_mfma_f32_16x16x32_bf16 v[64:67], v[160:163], v[224:227], v[64:67]
    v_mfma_f32_16x16x32_bf16 v[68:71], v[164:167], v[224:227], v[68:71]
    v_mfma_f32_16x16x32_bf16 v[68:71], v[160:163], v[228:231], v[68:71]
    v_mfma_f32_16x16x32_bf16 v[72:75], v[168:171], v[224:227], v[72:75]
    v_mfma_f32_16x16x32_bf16 v[72:75], v[164:167], v[228:231], v[72:75]
    v_mfma_f32_16x16x32_bf16 v[72:75], v[160:163], v[232:235], v[72:75]
    v_mfma_f32_16x16x32_bf16 v[76:79], v[172:175], v[224:227], v[76:79]
    v_mfma_f32_16x16x32_bf16 v[76:79], v[168:171], v[228:231], v[76:79]
    v_mfma_f32_16x16x32_bf16 v[76:79], v[164:167], v[232:235], v[76:79]
    v_mfma_f32_16x16x32_bf16 v[76:79], v[160:163], v[236:239], v[76:79]
    v_mfma_f32_16x16x32_bf16 v[80:83], v[176:179], v[224:227], v[80:83]
    v_mfma_f32_16x16x32_bf16 v[80:83], v[172:175], v[228:231], v[80:83]
    v_mfma_f32_16x16x32_bf16 v[80:83], v[168:171], v[232:235], v[80:83]
    v_mfma_f32_16x16x32_bf16 v[80:83], v[164:167], v[236:239], v[80:83]
    v_mfma_f32_16x16x32_bf16 v[80:83], v[160:163], v[240:243], v[80:83]
    v_mfma_f32_16x16x32_bf16 v[84:87], v[180:183], v[224:227], v[84:87]
    v_mfma_f32_16x16x32_bf16 v[84:87], v[176:179], v[228:231], v[84:87]
    v_mfma_f32_16x16x32_bf16 v[84:87], v[172:175], v[232:235], v[84:87]
    v_mfma_f32_16x16x32_bf16 v[84:87], v[168:171], v[236:239], v[84:87]
    v_mfma_f32_16x16x32_bf16 v[84:87], v[164:167], v[240:243], v[84:87]
    v_mfma_f32_16x16x32_bf16 v[84:87], v[160:163], v[244:247], v[84:87]
    v_mfma_f32_16x16x32_bf16 v[88:91], v[184:187], v[224:227], v[88:91]
    v_mfma_f32_16x16x32_bf16 v[88:91], v[180:183], v[228:231], v[88:91]
    v_mfma_f32_16x16x32_bf16 v[88:91], v[176:179], v[232:235], v[88:91]
    v_mfma_f32_16x16x32_bf16 v[88:91], v[172:175], v[236:239], v[88:91]
    v_mfma_f32_16x16x32_bf16 v[88:91], v[168:171], v[240:243], v[88:91]
    v_mfma_f32_16x16x32_bf16 v[88:91], v[164:167], v[244:247], v[88:91]
    v_mfma_f32_16x16x32_bf16 v[88:91], v[160:163], v[248:251], v[88:91]
    v_mfma_f32_16x16x32_bf16 v[92:95], v[188:191], v[224:227], v[92:95]
    v_mfma_f32_16x16x32_bf16 v[92:95], v[184:187], v[228:231], v[92:95]
    v_mfma_f32_16x16x32_bf16 v[92:95], v[180:183], v[232:235], v[92:95]
    v_mfma_f32_16x16x32_bf16 v[92:95], v[176:179], v[236:239], v[92:95]
    v_mfma_f32_16x16x32_bf16 v[92:95], v[172:175], v[240:243], v[92:95]
    v_mfma_f32_16x16x32_bf16 v[92:95], v[168:171], v[244:247], v[92:95]
    v_mfma_f32_16x16x32_bf16 v[92:95], v[164:167], v[248:251], v[92:95]
    v_mfma_f32_16x16x32_bf16 v[92:95], v[160:163], v[252:255], v[92:95]
    v_lshlrev_b32 v12, 7, v9
    v_lshl_add_u32 v12, v8, 2, v12
    v_add_u32 v12, s32, v12
    v_cvt_pk_bf16_f32 v40, v64, v65
    v_cvt_pk_bf16_f32 v41, v66, v67
    ds_write_b32 v12, v40 offset:0
    ds_write_b32 v12, v41 offset:64
    v_cvt_pk_bf16_f32 v42, v68, v69
    v_cvt_pk_bf16_f32 v43, v70, v71
    ds_write_b32 v12, v42 offset:512
    ds_write_b32 v12, v43 offset:576
    v_cvt_pk_bf16_f32 v40, v72, v73
    v_cvt_pk_bf16_f32 v41, v74, v75
    ds_write_b32 v12, v40 offset:1024
    ds_write_b32 v12, v41 offset:1088
    v_cvt_pk_bf16_f32 v42, v76, v77
    v_cvt_pk_bf16_f32 v43, v78, v79
    ds_write_b32 v12, v42 offset:1536
    ds_write_b32 v12, v43 offset:1600
    v_cvt_pk_bf16_f32 v40, v80, v81
    v_cvt_pk_bf16_f32 v41, v82, v83
    ds_write_b32 v12, v40 offset:2048
    ds_write_b32 v12, v41 offset:2112
    v_cvt_pk_bf16_f32 v42, v84, v85
    v_cvt_pk_bf16_f32 v43, v86, v87
    ds_write_b32 v12, v42 offset:2560
    ds_write_b32 v12, v43 offset:2624
    v_cvt_pk_bf16_f32 v40, v88, v89
    v_cvt_pk_bf16_f32 v41, v90, v91
    ds_write_b32 v12, v40 offset:3072
    ds_write_b32 v12, v41 offset:3136
    v_cvt_pk_bf16_f32 v42, v92, v93
    v_cvt_pk_bf16_f32 v43, v94, v95
    ds_write_b32 v12, v42 offset:3584
    ds_write_b32 v12, v43 offset:3648
    s_waitcnt lgkmcnt(0)
    s_lshl_b32 s52, s48, 16
    s_and_b32 s53, s48, 0xffff0000
    s_lshl_b32 s54, s49, 16
    s_and_b32 s55, s49, 0xffff0000
    s_lshl_b32 s56, s50, 16
    s_and_b32 s57, s50, 0xffff0000
    s_lshl_b32 s58, s51, 16
    s_and_b32 s59, s51, 0xffff0000
    s_barrier
    ds_read_b64 v[128:129], v6 offset:0
    ds_read_b64 v[130:131], v6 offset:16384
    ds_read_b64 v[132:133], v6 offset:32768
    ds_read_b64 v[134:135], v6 offset:49152
    ds_read_b64 v[136:137], v13 offset:0
    ds_read_b64 v[138:139], v13 offset:16384
    ds_read_b64 v[140:141], v13 offset:32768
    ds_read_b64 v[142:143], v13 offset:49152
    s_waitcnt lgkmcnt(0)
    v_lshlrev_b32 v176, 16, v96
    v_and_b32 v177, 0xffff0000, v96
    v_lshlrev_b32 v178, 16, v97
    v_and_b32 v179, 0xffff0000, v97
    v_mul_f32 v176, s52, v176
    v_mul_f32 v177, s52, v177
    v_mul_f32 v178, s52, v178
    v_mul_f32 v179, s52, v179
    v_cvt_pk_bf16_f32 v180, v176, v177
    v_cvt_pk_bf16_f32 v181, v178, v179
    v_lshlrev_b32 v176, 16, v180
    v_and_b32 v177, 0xffff0000, v180
    v_lshlrev_b32 v184, 16, v128
    v_and_b32 v185, 0xffff0000, v128
    v_lshlrev_b32 v178, 16, v181
    v_and_b32 v179, 0xffff0000, v181
    v_lshlrev_b32 v186, 16, v129
    v_and_b32 v187, 0xffff0000, v129
    v_add_f32 v176, v176, v184
    v_add_f32 v177, v177, v185
    v_add_f32 v178, v178, v186
    v_add_f32 v179, v179, v187
    v_cvt_pk_bf16_f32 v160, v176, v177
    v_cvt_pk_bf16_f32 v161, v178, v179
    v_lshlrev_b32 v192, 16, v98
    v_and_b32 v193, 0xffff0000, v98
    v_lshlrev_b32 v194, 16, v99
    v_and_b32 v195, 0xffff0000, v99
    v_mul_f32 v192, s53, v192
    v_mul_f32 v193, s53, v193
    v_mul_f32 v194, s53, v194
    v_mul_f32 v195, s53, v195
    v_cvt_pk_bf16_f32 v196, v192, v193
    v_cvt_pk_bf16_f32 v197, v194, v195
    v_lshlrev_b32 v192, 16, v196
    v_and_b32 v193, 0xffff0000, v196
    v_lshlrev_b32 v200, 16, v130
    v_and_b32 v201, 0xffff0000, v130
    v_lshlrev_b32 v194, 16, v197
    v_and_b32 v195, 0xffff0000, v197
    v_lshlrev_b32 v202, 16, v131
    v_and_b32 v203, 0xffff0000, v131
    v_add_f32 v192, v192, v200
    v_add_f32 v193, v193, v201
    v_add_f32 v194, v194, v202
    v_add_f32 v195, v195, v203
    v_cvt_pk_bf16_f32 v162, v192, v193
    v_cvt_pk_bf16_f32 v163, v194, v195
    v_lshlrev_b32 v176, 16, v100
    v_and_b32 v177, 0xffff0000, v100
    v_lshlrev_b32 v178, 16, v101
    v_and_b32 v179, 0xffff0000, v101
    v_mul_f32 v176, s54, v176
    v_mul_f32 v177, s54, v177
    v_mul_f32 v178, s54, v178
    v_mul_f32 v179, s54, v179
    v_cvt_pk_bf16_f32 v180, v176, v177
    v_cvt_pk_bf16_f32 v181, v178, v179
    v_lshlrev_b32 v176, 16, v180
    v_and_b32 v177, 0xffff0000, v180
    v_lshlrev_b32 v184, 16, v132
    v_and_b32 v185, 0xffff0000, v132
    v_lshlrev_b32 v178, 16, v181
    v_and_b32 v179, 0xffff0000, v181
    v_lshlrev_b32 v186, 16, v133
    v_and_b32 v187, 0xffff0000, v133
    v_add_f32 v176, v176, v184
    v_add_f32 v177, v177, v185
    v_add_f32 v178, v178, v186
    v_add_f32 v179, v179, v187
    v_cvt_pk_bf16_f32 v164, v176, v177
    v_cvt_pk_bf16_f32 v165, v178, v179
    v_lshlrev_b32 v192, 16, v102
    v_and_b32 v193, 0xffff0000, v102
    v_lshlrev_b32 v194, 16, v103
    v_and_b32 v195, 0xffff0000, v103
    v_mul_f32 v192, s55, v192
    v_mul_f32 v193, s55, v193
    v_mul_f32 v194, s55, v194
    v_mul_f32 v195, s55, v195
    v_cvt_pk_bf16_f32 v196, v192, v193
    v_cvt_pk_bf16_f32 v197, v194, v195
    v_lshlrev_b32 v192, 16, v196
    v_and_b32 v193, 0xffff0000, v196
    v_lshlrev_b32 v200, 16, v134
    v_and_b32 v201, 0xffff0000, v134
    v_lshlrev_b32 v194, 16, v197
    v_and_b32 v195, 0xffff0000, v197
    v_lshlrev_b32 v202, 16, v135
    v_and_b32 v203, 0xffff0000, v135
    v_add_f32 v192, v192, v200
    v_add_f32 v193, v193, v201
    v_add_f32 v194, v194, v202
    v_add_f32 v195, v195, v203
    v_cvt_pk_bf16_f32 v166, v192, v193
    v_cvt_pk_bf16_f32 v167, v194, v195
    v_lshlrev_b32 v176, 16, v104
    v_and_b32 v177, 0xffff0000, v104
    v_lshlrev_b32 v178, 16, v105
    v_and_b32 v179, 0xffff0000, v105
    v_mul_f32 v176, s56, v176
    v_mul_f32 v177, s56, v177
    v_mul_f32 v178, s56, v178
    v_mul_f32 v179, s56, v179
    v_cvt_pk_bf16_f32 v180, v176, v177
    v_cvt_pk_bf16_f32 v181, v178, v179
    v_lshlrev_b32 v176, 16, v180
    v_and_b32 v177, 0xffff0000, v180
    v_lshlrev_b32 v184, 16, v136
    v_and_b32 v185, 0xffff0000, v136
    v_lshlrev_b32 v178, 16, v181
    v_and_b32 v179, 0xffff0000, v181
    v_lshlrev_b32 v186, 16, v137
    v_and_b32 v187, 0xffff0000, v137
    v_add_f32 v176, v176, v184
    v_add_f32 v177, v177, v185
    v_add_f32 v178, v178, v186
    v_add_f32 v179, v179, v187
    v_cvt_pk_bf16_f32 v168, v176, v177
    v_cvt_pk_bf16_f32 v169, v178, v179
    v_lshlrev_b32 v192, 16, v106
    v_and_b32 v193, 0xffff0000, v106
    v_lshlrev_b32 v194, 16, v107
    v_and_b32 v195, 0xffff0000, v107
    v_mul_f32 v192, s57, v192
    v_mul_f32 v193, s57, v193
    v_mul_f32 v194, s57, v194
    v_mul_f32 v195, s57, v195
    v_cvt_pk_bf16_f32 v196, v192, v193
    v_cvt_pk_bf16_f32 v197, v194, v195
    v_lshlrev_b32 v192, 16, v196
    v_and_b32 v193, 0xffff0000, v196
    v_lshlrev_b32 v200, 16, v138
    v_and_b32 v201, 0xffff0000, v138
    v_lshlrev_b32 v194, 16, v197
    v_and_b32 v195, 0xffff0000, v197
    v_lshlrev_b32 v202, 16, v139
    v_and_b32 v203, 0xffff0000, v139
    v_add_f32 v192, v192, v200
    v_add_f32 v193, v193, v201
    v_add_f32 v194, v194, v202
    v_add_f32 v195, v195, v203
    v_cvt_pk_bf16_f32 v170, v192, v193
    v_cvt_pk_bf16_f32 v171, v194, v195
    v_lshlrev_b32 v176, 16, v108
    v_and_b32 v177, 0xffff0000, v108
    v_lshlrev_b32 v178, 16, v109
    v_and_b32 v179, 0xffff0000, v109
    v_mul_f32 v176, s58, v176
    v_mul_f32 v177, s58, v177
    v_mul_f32 v178, s58, v178
    v_mul_f32 v179, s58, v179
    v_cvt_pk_bf16_f32 v180, v176, v177
    v_cvt_pk_bf16_f32 v181, v178, v179
    v_lshlrev_b32 v176, 16, v180
    v_and_b32 v177, 0xffff0000, v180
    v_lshlrev_b32 v184, 16, v140
    v_and_b32 v185, 0xffff0000, v140
    v_lshlrev_b32 v178, 16, v181
    v_and_b32 v179, 0xffff0000, v181
    v_lshlrev_b32 v186, 16, v141
    v_and_b32 v187, 0xffff0000, v141
    v_add_f32 v176, v176, v184
    v_add_f32 v177, v177, v185
    v_add_f32 v178, v178, v186
    v_add_f32 v179, v179, v187
    v_cvt_pk_bf16_f32 v172, v176, v177
    v_cvt_pk_bf16_f32 v173, v178, v179
    v_lshlrev_b32 v192, 16, v110
    v_and_b32 v193, 0xffff0000, v110
    v_lshlrev_b32 v194, 16, v111
    v_and_b32 v195, 0xffff0000, v111
    v_mul_f32 v192, s59, v192
    v_mul_f32 v193, s59, v193
    v_mul_f32 v194, s59, v194
    v_mul_f32 v195, s59, v195
    v_cvt_pk_bf16_f32 v196, v192, v193
    v_cvt_pk_bf16_f32 v197, v194, v195
    v_lshlrev_b32 v192, 16, v196
    v_and_b32 v193, 0xffff0000, v196
    v_lshlrev_b32 v200, 16, v142
    v_and_b32 v201, 0xffff0000, v142
    v_lshlrev_b32 v194, 16, v197
    v_and_b32 v195, 0xffff0000, v197
    v_lshlrev_b32 v202, 16, v143
    v_and_b32 v203, 0xffff0000, v143
    v_add_f32 v192, v192, v200
    v_add_f32 v193, v193, v201
    v_add_f32 v194, v194, v202
    v_add_f32 v195, v195, v203
    v_cvt_pk_bf16_f32 v174, v192, v193
    v_cvt_pk_bf16_f32 v175, v194, v195
    v_lshlrev_b32 v2, 14, v0
    v_add_u32 v2, s26, v2
    v_add_u32 v2, 2048, v2
    s_mov_b32 s60, 0
    s_mov_b32 s61, 4096
    s_mov_b32 s62, 8192
    s_mov_b32 s63, 12288
    v_perm_b32 v208, v162, v160, s34
    v_perm_b32 v209, v166, v164, s34
    v_perm_b32 v210, v170, v168, s34
    v_perm_b32 v211, v174, v172, s34
    buffer_store_dwordx4 v[208:211], v2, s[8:11], s60 offen
    v_perm_b32 v212, v162, v160, s35
    v_perm_b32 v213, v166, v164, s35
    v_perm_b32 v214, v170, v168, s35
    v_perm_b32 v215, v174, v172, s35
    buffer_store_dwordx4 v[212:215], v2, s[8:11], s61 offen
    v_perm_b32 v216, v163, v161, s34
    v_perm_b32 v217, v167, v165, s34
    v_perm_b32 v218, v171, v169, s34
    v_perm_b32 v219, v175, v173, s34
    buffer_store_dwordx4 v[216:219], v2, s[8:11], s62 offen
    v_perm_b32 v220, v163, v161, s35
    v_perm_b32 v221, v167, v165, s35
    v_perm_b32 v222, v171, v169, s35
    v_perm_b32 v223, v175, v173, s35
    buffer_store_dwordx4 v[220:223], v2, s[8:11], s63 offen
    s_branch L_exit
    s_nop 0
L_exit:
    s_endpgm
.globl stage2_kernel
.p2align 8
.type stage2_kernel,@function
stage2_kernel:
    s_cmp_ge_u32 s2, 256
    s_cbranch_scc1 L_k2_exit
    s_load_dwordx2 s[4:5], s[0:1], 16
    s_load_dwordx2 s[46:47], s[0:1], 80
    s_load_dwordx2 s[42:43], s[0:1], 96
    v_and_b32 v1, 63, v0
    v_lshrrev_b32 v2, 6, v0
    s_mov_b32 s3, s2
    v_readfirstlane_b32 s24, v2
    s_waitcnt lgkmcnt(0)
    s_mov_b32 s12, s46
    s_and_b32 s13, s47, 0xffff
    s_mov_b32 s14, 8388608
    s_mov_b32 s15, 0x00020000
    s_mov_b32 s16, s42
    s_and_b32 s17, s43, 0xffff
    s_mov_b32 s18, 268435456
    s_mov_b32 s19, 0x00020000
    s_mov_b32 s20, s4
    s_and_b32 s21, s5, 0xffff
    s_mov_b32 s22, 2097152
    s_mov_b32 s23, 0x00020000
    s_lshr_b32 s25, s3, 1
    s_and_b32 s25, s25, 3
    s_lshl_b32 s25, s25, 3
    s_lshr_b32 s32, s3, 3
    s_and_b32 s33, s32, 7
    s_add_u32 s25, s25, s33
    s_and_b32 s26, s3, 1
    s_lshl_b32 s26, s26, 2
    s_lshr_b32 s33, s32, 3
    s_add_u32 s26, s26, s33
    s_and_b32 s40, s24, 1
    s_lshr_b32 s41, s24, 1
    v_lshrrev_b32 v12, 2, v1
    v_lshlrev_b32 v14, 11, v12
    v_and_b32 v13, 3, v1
    v_lshl_add_u32 v14, v13, 4, v14
    s_lshl_b32 s35, s41, 20
    s_lshl_b32 s34, s40, 7
    s_add_u32 s35, s35, s34
    s_lshl_b32 s34, s26, 8
    s_add_u32 s35, s35, s34
    v_add_u32 v2, s35, v14
    v_add_u32 v3, 31744, v2
    v_add_u32 v4, -1984, v2
    v_add_u32 v5, -1984, v3
    v_lshlrev_b32 v6, 4, v1
    s_lshl_b32 s30, s24, 12
    s_cmp_ge_u32 s24, 2
    s_cbranch_scc1 L_noz_6
    s_lshl_b32 s34, s24, 10
    s_add_u32 m0, s34, 65536
    s_add_u32 s34, s34, 7405568
    buffer_load_dwordx4 v6, s[16:19], s34 offen lds
L_noz_6:
    s_lshl_b32 s28, s25, 1
    s_add_u32 s28, s28, s40
    s_lshl_b32 s28, s28, 16
    s_lshl_b32 s34, s41, 15
    s_add_u32 s28, s28, s34
    s_add_u32 s29, s34, 7340032
    s_add_u32 s36, s28, 0
    buffer_load_dwordx4 v[208:211], v6, s[16:19], s36 offen
    buffer_load_dwordx4 v[212:215], v6, s[16:19], s36 offen offset:1024
    s_add_u32 s37, s29, 0
    buffer_load_dwordx4 v[216:219], v6, s[16:19], s37 offen
    buffer_load_dwordx4 v[220:223], v6, s[16:19], s37 offen offset:1024
    s_add_u32 m0, s30, 0
    s_mov_b32 s27, 0
    buffer_load_dwordx4 v2, s[20:23], s27 offen offset:0 lds
    buffer_load_dwordx4 v3, s[20:23], s27 offen offset:1024 lds
    buffer_load_dwordx4 v4, s[20:23], s27 offen offset:2048 lds
    buffer_load_dwordx4 v5, s[20:23], s27 offen offset:3072 lds
    s_add_u32 s36, s28, 2048
    buffer_load_dwordx4 v[224:227], v6, s[16:19], s36 offen
    buffer_load_dwordx4 v[228:231], v6, s[16:19], s36 offen offset:1024
    s_add_u32 s37, s29, 2048
    buffer_load_dwordx4 v[232:235], v6, s[16:19], s37 offen
    buffer_load_dwordx4 v[236:239], v6, s[16:19], s37 offen offset:1024
    s_add_u32 m0, s30, 16384
    s_mov_b32 s27, 65536
    buffer_load_dwordx4 v2, s[20:23], s27 offen offset:0 lds
    buffer_load_dwordx4 v3, s[20:23], s27 offen offset:1024 lds
    buffer_load_dwordx4 v4, s[20:23], s27 offen offset:2048 lds
    buffer_load_dwordx4 v5, s[20:23], s27 offen offset:3072 lds
    s_add_u32 s36, s28, 4096
    buffer_load_dwordx4 v[240:243], v6, s[16:19], s36 offen
    buffer_load_dwordx4 v[244:247], v6, s[16:19], s36 offen offset:1024
    s_add_u32 s37, s29, 4096
    buffer_load_dwordx4 v[248:251], v6, s[16:19], s37 offen
    buffer_load_dwordx4 v[252:255], v6, s[16:19], s37 offen offset:1024
    s_add_u32 m0, s30, 32768
    s_mov_b32 s27, 131072
    buffer_load_dwordx4 v2, s[20:23], s27 offen offset:0 lds
    buffer_load_dwordx4 v3, s[20:23], s27 offen offset:1024 lds
    buffer_load_dwordx4 v4, s[20:23], s27 offen offset:2048 lds
    buffer_load_dwordx4 v5, s[20:23], s27 offen offset:3072 lds
    v_lshrrev_b32 v12, 5, v1
    v_lshlrev_b32 v7, 4, v12
    s_lshl_b32 s34, s41, 10
    s_add_u32 s34, s34, 65536
    v_add_u32 v7, s34, v7
    v_lshlrev_b32 v12, 2, v12
    v_bfe_u32 v13, v1, 2, 2
    v_add_u32 v12, v12, v13
    v_lshlrev_b32 v12, 6, v12
    v_bfe_u32 v13, v1, 4, 1
    v_lshl_add_u32 v12, v13, 5, v12
    v_and_b32 v13, 3, v1
    v_lshl_add_u32 v11, v13, 3, v12
    s_lshl_b32 s34, s41, 13
    v_add_u32 v11, s34, v11
    s_mov_b32 s38, 0x358637bd
    s_waitcnt vmcnt(16)
    s_barrier
    ds_read_b128 v[24:27], v7 offset:0
    ds_read_b128 v[28:31], v7 offset:32
    ds_read_b128 v[32:35], v7 offset:64
    ds_read_b128 v[36:39], v7 offset:96
    ds_read_b64_tr_b16 v[72:73], v11 offset:0
    ds_read_b64_tr_b16 v[74:75], v11 offset:512
    ds_read_b64_tr_b16 v[76:77], v11 offset:2048
    ds_read_b64_tr_b16 v[78:79], v11 offset:2560
    ds_read_b64_tr_b16 v[80:81], v11 offset:4096
    ds_read_b64_tr_b16 v[82:83], v11 offset:4608
    ds_read_b64_tr_b16 v[84:85], v11 offset:6144
    ds_read_b64_tr_b16 v[86:87], v11 offset:6656
    ds_read_b64_tr_b16 v[88:89], v11 offset:1024
    ds_read_b64_tr_b16 v[90:91], v11 offset:1536
    ds_read_b64_tr_b16 v[92:93], v11 offset:3072
    ds_read_b64_tr_b16 v[94:95], v11 offset:3584
    ds_read_b64_tr_b16 v[96:97], v11 offset:5120
    ds_read_b64_tr_b16 v[98:99], v11 offset:5632
    ds_read_b64_tr_b16 v[100:101], v11 offset:7168
    ds_read_b64_tr_b16 v[102:103], v11 offset:7680
    s_waitcnt lgkmcnt(0)
    v_mfma_f32_32x32x16_bf16 v[40:55], v[216:219], v[208:211], 0
    v_mfma_f32_32x32x16_bf16 v[40:55], v[220:223], v[212:215], v[40:55]
    v_dot2_f32_bf16 v16, v208, v24, 0
    v_dot2_f32_bf16 v17, v209, v25, 0
    v_dot2_f32_bf16 v18, v210, v26, 0
    v_dot2_f32_bf16 v19, v211, v27, 0
    v_dot2_f32_bf16 v16, v212, v28, v16
    v_dot2_f32_bf16 v17, v213, v29, v17
    v_dot2_f32_bf16 v18, v214, v30, v18
    v_dot2_f32_bf16 v19, v215, v31, v19
    s_nop 0
    v_add_f32 v16, v16, v17
    s_nop 0
    v_add_f32 v18, v18, v19
    v_add_f32 v16, v16, v18
    v_mov_b32 v17, v16
    s_nop 1
    v_permlane32_swap_b32 v16, v17
    v_add_f32 v16, v16, v17
    v_cvt_pk_bf16_f32 v16, v16, v16
    v_and_b32 v16, 0xffff0000, v16
    v_add_f32 v16, s38, v16
    v_cvt_pk_bf16_f32 v16, v16, v16
    v_and_b32 v16, 0xffff0000, v16
    v_rcp_f32 v16, v16
    s_nop 0
    v_mul_f32 v40, v40, v16
    v_mul_f32 v41, v41, v16
    v_cvt_pk_bf16_f32 v56, v40, v41
    v_mul_f32 v42, v42, v16
    v_mul_f32 v43, v43, v16
    v_cvt_pk_bf16_f32 v57, v42, v43
    v_mul_f32 v44, v44, v16
    v_mul_f32 v45, v45, v16
    v_cvt_pk_bf16_f32 v58, v44, v45
    v_mul_f32 v46, v46, v16
    v_mul_f32 v47, v47, v16
    v_cvt_pk_bf16_f32 v59, v46, v47
    v_mul_f32 v48, v48, v16
    v_mul_f32 v49, v49, v16
    v_cvt_pk_bf16_f32 v60, v48, v49
    v_mul_f32 v50, v50, v16
    v_mul_f32 v51, v51, v16
    v_cvt_pk_bf16_f32 v61, v50, v51
    v_mul_f32 v52, v52, v16
    v_mul_f32 v53, v53, v16
    v_cvt_pk_bf16_f32 v62, v52, v53
    v_mul_f32 v54, v54, v16
    v_mul_f32 v55, v55, v16
    v_cvt_pk_bf16_f32 v63, v54, v55
    s_waitcnt lgkmcnt(0)
    s_waitcnt vmcnt(12)
    v_mfma_f32_32x32x16_bf16 v[40:55], v[232:235], v[224:227], 0
    v_mfma_f32_32x32x16_bf16 v[40:55], v[236:239], v[228:231], v[40:55]
    s_waitcnt vmcnt(8)
    s_barrier
    v_mfma_f32_32x32x16_bf16 v[136:151], v[72:75], v[56:59], 0
    ds_read_b64_tr_b16 v[104:105], v11 offset:16384
    ds_read_b64_tr_b16 v[106:107], v11 offset:16896
    ds_read_b64_tr_b16 v[108:109], v11 offset:18432
    ds_read_b64_tr_b16 v[110:111], v11 offset:18944
    ds_read_b64_tr_b16 v[112:113], v11 offset:20480
    ds_read_b64_tr_b16 v[114:115], v11 offset:20992
    ds_read_b64_tr_b16 v[116:117], v11 offset:22528
    ds_read_b64_tr_b16 v[118:119], v11 offset:23040
    v_mfma_f32_32x32x16_bf16 v[152:167], v[76:79], v[56:59], 0
    ds_read_b64_tr_b16 v[120:121], v11 offset:17408
    ds_read_b64_tr_b16 v[122:123], v11 offset:17920
    ds_read_b64_tr_b16 v[124:125], v11 offset:19456
    ds_read_b64_tr_b16 v[126:127], v11 offset:19968
    ds_read_b64_tr_b16 v[128:129], v11 offset:21504
    ds_read_b64_tr_b16 v[130:131], v11 offset:22016
    ds_read_b64_tr_b16 v[132:133], v11 offset:23552
    ds_read_b64_tr_b16 v[134:135], v11 offset:24064
    s_add_u32 m0, s30, 49152
    s_mov_b32 s27, 196608
    buffer_load_dwordx4 v2, s[20:23], s27 offen offset:0 lds
    buffer_load_dwordx4 v3, s[20:23], s27 offen offset:1024 lds
    buffer_load_dwordx4 v4, s[20:23], s27 offen offset:2048 lds
    buffer_load_dwordx4 v5, s[20:23], s27 offen offset:3072 lds
    v_mfma_f32_32x32x16_bf16 v[168:183], v[80:83], v[56:59], 0
    v_dot2_f32_bf16 v16, v224, v32, 0
    v_dot2_f32_bf16 v17, v225, v33, 0
    v_dot2_f32_bf16 v18, v226, v34, 0
    v_dot2_f32_bf16 v19, v227, v35, 0
    v_dot2_f32_bf16 v16, v228, v36, v16
    v_dot2_f32_bf16 v17, v229, v37, v17
    v_dot2_f32_bf16 v18, v230, v38, v18
    v_dot2_f32_bf16 v19, v231, v39, v19
    v_mfma_f32_32x32x16_bf16 v[184:199], v[84:87], v[56:59], 0
    v_add_f32 v16, v16, v17
    s_nop 0
    v_add_f32 v18, v18, v19
    v_add_f32 v16, v16, v18
    v_mov_b32 v17, v16
    s_nop 1
    v_permlane32_swap_b32 v16, v17
    v_add_f32 v16, v16, v17
    v_cvt_pk_bf16_f32 v16, v16, v16
    v_and_b32 v16, 0xffff0000, v16
    s_add_u32 s36, s28, 6144
    buffer_load_dwordx4 v[208:211], v6, s[16:19], s36 offen
    buffer_load_dwordx4 v[212:215], v6, s[16:19], s36 offen offset:1024
    s_add_u32 s37, s29, 6144
    buffer_load_dwordx4 v[216:219], v6, s[16:19], s37 offen
    buffer_load_dwordx4 v[220:223], v6, s[16:19], s37 offen offset:1024
    v_mfma_f32_32x32x16_bf16 v[136:151], v[88:91], v[60:63], v[136:151]
    v_add_f32 v16, s38, v16
    v_cvt_pk_bf16_f32 v16, v16, v16
    v_and_b32 v16, 0xffff0000, v16
    v_rcp_f32 v16, v16
    ds_read_b128 v[24:27], v7 offset:128
    ds_read_b128 v[28:31], v7 offset:160
    v_mul_f32 v40, v40, v16
    v_mul_f32 v41, v41, v16
    v_mfma_f32_32x32x16_bf16 v[152:167], v[92:95], v[60:63], v[152:167]
    v_cvt_pk_bf16_f32 v64, v40, v41
    v_mul_f32 v42, v42, v16
    v_mul_f32 v43, v43, v16
    v_cvt_pk_bf16_f32 v65, v42, v43
    v_mul_f32 v44, v44, v16
    v_mul_f32 v45, v45, v16
    v_cvt_pk_bf16_f32 v66, v44, v45
    v_mul_f32 v46, v46, v16
    v_mfma_f32_32x32x16_bf16 v[168:183], v[96:99], v[60:63], v[168:183]
    v_mul_f32 v47, v47, v16
    v_cvt_pk_bf16_f32 v67, v46, v47
    v_mul_f32 v48, v48, v16
    v_mul_f32 v49, v49, v16
    v_cvt_pk_bf16_f32 v68, v48, v49
    v_mul_f32 v50, v50, v16
    v_mul_f32 v51, v51, v16
    v_cvt_pk_bf16_f32 v69, v50, v51
    v_mfma_f32_32x32x16_bf16 v[184:199], v[100:103], v[60:63], v[184:199]
    v_mul_f32 v52, v52, v16
    v_mul_f32 v53, v53, v16
    v_cvt_pk_bf16_f32 v70, v52, v53
    v_mul_f32 v54, v54, v16
    v_mul_f32 v55, v55, v16
    v_cvt_pk_bf16_f32 v71, v54, v55
    s_waitcnt lgkmcnt(0)
    s_waitcnt vmcnt(12)
    v_mfma_f32_32x32x16_bf16 v[40:55], v[248:251], v[240:243], 0
    v_mfma_f32_32x32x16_bf16 v[40:55], v[252:255], v[244:247], v[40:55]
    s_waitcnt vmcnt(8)
    s_barrier
    v_mfma_f32_32x32x16_bf16 v[136:151], v[104:107], v[64:67], v[136:151]
    ds_read_b64_tr_b16 v[72:73], v11 offset:32768
    ds_read_b64_tr_b16 v[74:75], v11 offset:33280
    ds_read_b64_tr_b16 v[76:77], v11 offset:34816
    ds_read_b64_tr_b16 v[78:79], v11 offset:35328
    ds_read_b64_tr_b16 v[80:81], v11 offset:36864
    ds_read_b64_tr_b16 v[82:83], v11 offset:37376
    ds_read_b64_tr_b16 v[84:85], v11 offset:38912
    ds_read_b64_tr_b16 v[86:87], v11 offset:39424
    v_mfma_f32_32x32x16_bf16 v[152:167], v[108:111], v[64:67], v[152:167]
    ds_read_b64_tr_b16 v[88:89], v11 offset:33792
    ds_read_b64_tr_b16 v[90:91], v11 offset:34304
    ds_read_b64_tr_b16 v[92:93], v11 offset:35840
    ds_read_b64_tr_b16 v[94:95], v11 offset:36352
    ds_read_b64_tr_b16 v[96:97], v11 offset:37888
    ds_read_b64_tr_b16 v[98:99], v11 offset:38400
    ds_read_b64_tr_b16 v[100:101], v11 offset:39936
    ds_read_b64_tr_b16 v[102:103], v11 offset:40448
    s_add_u32 m0, s30, 0
    s_mov_b32 s27, 262144
    buffer_load_dwordx4 v2, s[20:23], s27 offen offset:0 lds
    buffer_load_dwordx4 v3, s[20:23], s27 offen offset:1024 lds
    buffer_load_dwordx4 v4, s[20:23], s27 offen offset:2048 lds
    buffer_load_dwordx4 v5, s[20:23], s27 offen offset:3072 lds
    v_mfma_f32_32x32x16_bf16 v[168:183], v[112:115], v[64:67], v[168:183]
    v_dot2_f32_bf16 v16, v240, v24, 0
    v_dot2_f32_bf16 v17, v241, v25, 0
    v_dot2_f32_bf16 v18, v242, v26, 0
    v_dot2_f32_bf16 v19, v243, v27, 0
    v_dot2_f32_bf16 v16, v244, v28, v16
    v_dot2_f32_bf16 v17, v245, v29, v17
    v_dot2_f32_bf16 v18, v246, v30, v18
    v_dot2_f32_bf16 v19, v247, v31, v19
    v_mfma_f32_32x32x16_bf16 v[184:199], v[116:119], v[64:67], v[184:199]
    v_add_f32 v16, v16, v17
    s_nop 0
    v_add_f32 v18, v18, v19
    v_add_f32 v16, v16, v18
    v_mov_b32 v17, v16
    s_nop 1
    v_permlane32_swap_b32 v16, v17
    v_add_f32 v16, v16, v17
    v_cvt_pk_bf16_f32 v16, v16, v16
    v_and_b32 v16, 0xffff0000, v16
    s_add_u32 s36, s28, 8192
    buffer_load_dwordx4 v[224:227], v6, s[16:19], s36 offen
    buffer_load_dwordx4 v[228:231], v6, s[16:19], s36 offen offset:1024
    s_add_u32 s37, s29, 8192
    buffer_load_dwordx4 v[232:235], v6, s[16:19], s37 offen
    buffer_load_dwordx4 v[236:239], v6, s[16:19], s37 offen offset:1024
    v_mfma_f32_32x32x16_bf16 v[136:151], v[120:123], v[68:71], v[136:151]
    v_add_f32 v16, s38, v16
    v_cvt_pk_bf16_f32 v16, v16, v16
    v_and_b32 v16, 0xffff0000, v16
    v_rcp_f32 v16, v16
    ds_read_b128 v[32:35], v7 offset:192
    ds_read_b128 v[36:39], v7 offset:224
    v_mul_f32 v40, v40, v16
    v_mul_f32 v41, v41, v16
    v_mfma_f32_32x32x16_bf16 v[152:167], v[124:127], v[68:71], v[152:167]
    v_cvt_pk_bf16_f32 v56, v40, v41
    v_mul_f32 v42, v42, v16
    v_mul_f32 v43, v43, v16
    v_cvt_pk_bf16_f32 v57, v42, v43
    v_mul_f32 v44, v44, v16
    v_mul_f32 v45, v45, v16
    v_cvt_pk_bf16_f32 v58, v44, v45
    v_mul_f32 v46, v46, v16
    v_mfma_f32_32x32x16_bf16 v[168:183], v[128:131], v[68:71], v[168:183]
    v_mul_f32 v47, v47, v16
    v_cvt_pk_bf16_f32 v59, v46, v47
    v_mul_f32 v48, v48, v16
    v_mul_f32 v49, v49, v16
    v_cvt_pk_bf16_f32 v60, v48, v49
    v_mul_f32 v50, v50, v16
    v_mul_f32 v51, v51, v16
    v_cvt_pk_bf16_f32 v61, v50, v51
    v_mfma_f32_32x32x16_bf16 v[184:199], v[132:135], v[68:71], v[184:199]
    v_mul_f32 v52, v52, v16
    v_mul_f32 v53, v53, v16
    v_cvt_pk_bf16_f32 v62, v52, v53
    v_mul_f32 v54, v54, v16
    v_mul_f32 v55, v55, v16
    v_cvt_pk_bf16_f32 v63, v54, v55
    s_waitcnt lgkmcnt(0)
    s_waitcnt vmcnt(8)
    v_mfma_f32_32x32x16_bf16 v[40:55], v[216:219], v[208:211], 0
    v_mfma_f32_32x32x16_bf16 v[40:55], v[220:223], v[212:215], v[40:55]
    s_barrier
    v_mfma_f32_32x32x16_bf16 v[136:151], v[72:75], v[56:59], v[136:151]
    ds_read_b64_tr_b16 v[104:105], v11 offset:49152
    ds_read_b64_tr_b16 v[106:107], v11 offset:49664
    ds_read_b64_tr_b16 v[108:109], v11 offset:51200
    ds_read_b64_tr_b16 v[110:111], v11 offset:51712
    ds_read_b64_tr_b16 v[112:113], v11 offset:53248
    ds_read_b64_tr_b16 v[114:115], v11 offset:53760
    ds_read_b64_tr_b16 v[116:117], v11 offset:55296
    ds_read_b64_tr_b16 v[118:119], v11 offset:55808
    v_mfma_f32_32x32x16_bf16 v[152:167], v[76:79], v[56:59], v[152:167]
    ds_read_b64_tr_b16 v[120:121], v11 offset:50176
    ds_read_b64_tr_b16 v[122:123], v11 offset:50688
    ds_read_b64_tr_b16 v[124:125], v11 offset:52224
    ds_read_b64_tr_b16 v[126:127], v11 offset:52736
    ds_read_b64_tr_b16 v[128:129], v11 offset:54272
    ds_read_b64_tr_b16 v[130:131], v11 offset:54784
    ds_read_b64_tr_b16 v[132:133], v11 offset:56320
    ds_read_b64_tr_b16 v[134:135], v11 offset:56832
    s_add_u32 m0, s30, 16384
    s_mov_b32 s27, 327680
    buffer_load_dwordx4 v2, s[20:23], s27 offen offset:0 lds
    buffer_load_dwordx4 v3, s[20:23], s27 offen offset:1024 lds
    buffer_load_dwordx4 v4, s[20:23], s27 offen offset:2048 lds
    buffer_load_dwordx4 v5, s[20:23], s27 offen offset:3072 lds
    v_mfma_f32_32x32x16_bf16 v[168:183], v[80:83], v[56:59], v[168:183]
    v_dot2_f32_bf16 v16, v208, v32, 0
    v_dot2_f32_bf16 v17, v209, v33, 0
    v_dot2_f32_bf16 v18, v210, v34, 0
    v_dot2_f32_bf16 v19, v211, v35, 0
    v_dot2_f32_bf16 v16, v212, v36, v16
    v_dot2_f32_bf16 v17, v213, v37, v17
    v_dot2_f32_bf16 v18, v214, v38, v18
    v_dot2_f32_bf16 v19, v215, v39, v19
    v_mfma_f32_32x32x16_bf16 v[184:199], v[84:87], v[56:59], v[184:199]
    v_add_f32 v16, v16, v17
    s_nop 0
    v_add_f32 v18, v18, v19
    v_add_f32 v16, v16, v18
    v_mov_b32 v17, v16
    s_nop 1
    v_permlane32_swap_b32 v16, v17
    v_add_f32 v16, v16, v17
    v_cvt_pk_bf16_f32 v16, v16, v16
    v_and_b32 v16, 0xffff0000, v16
    s_add_u32 s36, s28, 10240
    buffer_load_dwordx4 v[240:243], v6, s[16:19], s36 offen
    buffer_load_dwordx4 v[244:247], v6, s[16:19], s36 offen offset:1024
    s_add_u32 s37, s29, 10240
    buffer_load_dwordx4 v[248:251], v6, s[16:19], s37 offen
    buffer_load_dwordx4 v[252:255], v6, s[16:19], s37 offen offset:1024
    v_mfma_f32_32x32x16_bf16 v[136:151], v[88:91], v[60:63], v[136:151]
    v_add_f32 v16, s38, v16
    v_cvt_pk_bf16_f32 v16, v16, v16
    v_and_b32 v16, 0xffff0000, v16
    v_rcp_f32 v16, v16
    ds_read_b128 v[24:27], v7 offset:256
    ds_read_b128 v[28:31], v7 offset:288
    v_mul_f32 v40, v40, v16
    v_mul_f32 v41, v41, v16
    v_mfma_f32_32x32x16_bf16 v[152:167], v[92:95], v[60:63], v[152:167]
    v_cvt_pk_bf16_f32 v64, v40, v41
    v_mul_f32 v42, v42, v16
    v_mul_f32 v43, v43, v16
    v_cvt_pk_bf16_f32 v65, v42, v43
    v_mul_f32 v44, v44, v16
    v_mul_f32 v45, v45, v16
    v_cvt_pk_bf16_f32 v66, v44, v45
    v_mul_f32 v46, v46, v16
    v_mfma_f32_32x32x16_bf16 v[168:183], v[96:99], v[60:63], v[168:183]
    v_mul_f32 v47, v47, v16
    v_cvt_pk_bf16_f32 v67, v46, v47
    v_mul_f32 v48, v48, v16
    v_mul_f32 v49, v49, v16
    v_cvt_pk_bf16_f32 v68, v48, v49
    v_mul_f32 v50, v50, v16
    v_mul_f32 v51, v51, v16
    v_cvt_pk_bf16_f32 v69, v50, v51
    v_mfma_f32_32x32x16_bf16 v[184:199], v[100:103], v[60:63], v[184:199]
    v_mul_f32 v52, v52, v16
    v_mul_f32 v53, v53, v16
    v_cvt_pk_bf16_f32 v70, v52, v53
    v_mul_f32 v54, v54, v16
    v_mul_f32 v55, v55, v16
    v_cvt_pk_bf16_f32 v71, v54, v55
    s_waitcnt lgkmcnt(0)
    s_waitcnt vmcnt(8)
    v_mfma_f32_32x32x16_bf16 v[40:55], v[232:235], v[224:227], 0
    v_mfma_f32_32x32x16_bf16 v[40:55], v[236:239], v[228:231], v[40:55]
    s_barrier
    v_mfma_f32_32x32x16_bf16 v[136:151], v[104:107], v[64:67], v[136:151]
    ds_read_b64_tr_b16 v[72:73], v11 offset:0
    ds_read_b64_tr_b16 v[74:75], v11 offset:512
    ds_read_b64_tr_b16 v[76:77], v11 offset:2048
    ds_read_b64_tr_b16 v[78:79], v11 offset:2560
    ds_read_b64_tr_b16 v[80:81], v11 offset:4096
    ds_read_b64_tr_b16 v[82:83], v11 offset:4608
    ds_read_b64_tr_b16 v[84:85], v11 offset:6144
    ds_read_b64_tr_b16 v[86:87], v11 offset:6656
    v_mfma_f32_32x32x16_bf16 v[152:167], v[108:111], v[64:67], v[152:167]
    ds_read_b64_tr_b16 v[88:89], v11 offset:1024
    ds_read_b64_tr_b16 v[90:91], v11 offset:1536
    ds_read_b64_tr_b16 v[92:93], v11 offset:3072
    ds_read_b64_tr_b16 v[94:95], v11 offset:3584
    ds_read_b64_tr_b16 v[96:97], v11 offset:5120
    ds_read_b64_tr_b16 v[98:99], v11 offset:5632
    ds_read_b64_tr_b16 v[100:101], v11 offset:7168
    ds_read_b64_tr_b16 v[102:103], v11 offset:7680
    s_add_u32 m0, s30, 32768
    s_mov_b32 s27, 393216
    buffer_load_dwordx4 v2, s[20:23], s27 offen offset:0 lds
    buffer_load_dwordx4 v3, s[20:23], s27 offen offset:1024 lds
    buffer_load_dwordx4 v4, s[20:23], s27 offen offset:2048 lds
    buffer_load_dwordx4 v5, s[20:23], s27 offen offset:3072 lds
    v_mfma_f32_32x32x16_bf16 v[168:183], v[112:115], v[64:67], v[168:183]
    v_dot2_f32_bf16 v16, v224, v24, 0
    v_dot2_f32_bf16 v17, v225, v25, 0
    v_dot2_f32_bf16 v18, v226, v26, 0
    v_dot2_f32_bf16 v19, v227, v27, 0
    v_dot2_f32_bf16 v16, v228, v28, v16
    v_dot2_f32_bf16 v17, v229, v29, v17
    v_dot2_f32_bf16 v18, v230, v30, v18
    v_dot2_f32_bf16 v19, v231, v31, v19
    v_mfma_f32_32x32x16_bf16 v[184:199], v[116:119], v[64:67], v[184:199]
    v_add_f32 v16, v16, v17
    s_nop 0
    v_add_f32 v18, v18, v19
    v_add_f32 v16, v16, v18
    v_mov_b32 v17, v16
    s_nop 1
    v_permlane32_swap_b32 v16, v17
    v_add_f32 v16, v16, v17
    v_cvt_pk_bf16_f32 v16, v16, v16
    v_and_b32 v16, 0xffff0000, v16
    s_add_u32 s36, s28, 12288
    buffer_load_dwordx4 v[208:211], v6, s[16:19], s36 offen
    buffer_load_dwordx4 v[212:215], v6, s[16:19], s36 offen offset:1024
    s_add_u32 s37, s29, 12288
    buffer_load_dwordx4 v[216:219], v6, s[16:19], s37 offen
    buffer_load_dwordx4 v[220:223], v6, s[16:19], s37 offen offset:1024
    v_mfma_f32_32x32x16_bf16 v[136:151], v[120:123], v[68:71], v[136:151]
    v_add_f32 v16, s38, v16
    v_cvt_pk_bf16_f32 v16, v16, v16
    v_and_b32 v16, 0xffff0000, v16
    v_rcp_f32 v16, v16
    ds_read_b128 v[32:35], v7 offset:320
    ds_read_b128 v[36:39], v7 offset:352
    v_mul_f32 v40, v40, v16
    v_mul_f32 v41, v41, v16
    v_mfma_f32_32x32x16_bf16 v[152:167], v[124:127], v[68:71], v[152:167]
    v_cvt_pk_bf16_f32 v56, v40, v41
    v_mul_f32 v42, v42, v16
    v_mul_f32 v43, v43, v16
    v_cvt_pk_bf16_f32 v57, v42, v43
    v_mul_f32 v44, v44, v16
    v_mul_f32 v45, v45, v16
    v_cvt_pk_bf16_f32 v58, v44, v45
    v_mul_f32 v46, v46, v16
    v_mfma_f32_32x32x16_bf16 v[168:183], v[128:131], v[68:71], v[168:183]
    v_mul_f32 v47, v47, v16
    v_cvt_pk_bf16_f32 v59, v46, v47
    v_mul_f32 v48, v48, v16
    v_mul_f32 v49, v49, v16
    v_cvt_pk_bf16_f32 v60, v48, v49
    v_mul_f32 v50, v50, v16
    v_mul_f32 v51, v51, v16
    v_cvt_pk_bf16_f32 v61, v50, v51
    v_mfma_f32_32x32x16_bf16 v[184:199], v[132:135], v[68:71], v[184:199]
    v_mul_f32 v52, v52, v16
    v_mul_f32 v53, v53, v16
    v_cvt_pk_bf16_f32 v62, v52, v53
    v_mul_f32 v54, v54, v16
    v_mul_f32 v55, v55, v16
    v_cvt_pk_bf16_f32 v63, v54, v55
    s_waitcnt lgkmcnt(0)
    s_waitcnt vmcnt(8)
    v_mfma_f32_32x32x16_bf16 v[40:55], v[248:251], v[240:243], 0
    v_mfma_f32_32x32x16_bf16 v[40:55], v[252:255], v[244:247], v[40:55]
    s_barrier
    v_mfma_f32_32x32x16_bf16 v[136:151], v[72:75], v[56:59], v[136:151]
    ds_read_b64_tr_b16 v[104:105], v11 offset:16384
    ds_read_b64_tr_b16 v[106:107], v11 offset:16896
    ds_read_b64_tr_b16 v[108:109], v11 offset:18432
    ds_read_b64_tr_b16 v[110:111], v11 offset:18944
    ds_read_b64_tr_b16 v[112:113], v11 offset:20480
    ds_read_b64_tr_b16 v[114:115], v11 offset:20992
    ds_read_b64_tr_b16 v[116:117], v11 offset:22528
    ds_read_b64_tr_b16 v[118:119], v11 offset:23040
    v_mfma_f32_32x32x16_bf16 v[152:167], v[76:79], v[56:59], v[152:167]
    ds_read_b64_tr_b16 v[120:121], v11 offset:17408
    ds_read_b64_tr_b16 v[122:123], v11 offset:17920
    ds_read_b64_tr_b16 v[124:125], v11 offset:19456
    ds_read_b64_tr_b16 v[126:127], v11 offset:19968
    ds_read_b64_tr_b16 v[128:129], v11 offset:21504
    ds_read_b64_tr_b16 v[130:131], v11 offset:22016
    ds_read_b64_tr_b16 v[132:133], v11 offset:23552
    ds_read_b64_tr_b16 v[134:135], v11 offset:24064
    s_add_u32 m0, s30, 49152
    s_mov_b32 s27, 458752
    buffer_load_dwordx4 v2, s[20:23], s27 offen offset:0 lds
    buffer_load_dwordx4 v3, s[20:23], s27 offen offset:1024 lds
    buffer_load_dwordx4 v4, s[20:23], s27 offen offset:2048 lds
    buffer_load_dwordx4 v5, s[20:23], s27 offen offset:3072 lds
    v_mfma_f32_32x32x16_bf16 v[168:183], v[80:83], v[56:59], v[168:183]
    v_dot2_f32_bf16 v16, v240, v32, 0
    v_dot2_f32_bf16 v17, v241, v33, 0
    v_dot2_f32_bf16 v18, v242, v34, 0
    v_dot2_f32_bf16 v19, v243, v35, 0
    v_dot2_f32_bf16 v16, v244, v36, v16
    v_dot2_f32_bf16 v17, v245, v37, v17
    v_dot2_f32_bf16 v18, v246, v38, v18
    v_dot2_f32_bf16 v19, v247, v39, v19
    v_mfma_f32_32x32x16_bf16 v[184:199], v[84:87], v[56:59], v[184:199]
    v_add_f32 v16, v16, v17
    s_nop 0
    v_add_f32 v18, v18, v19
    v_add_f32 v16, v16, v18
    v_mov_b32 v17, v16
    s_nop 1
    v_permlane32_swap_b32 v16, v17
    v_add_f32 v16, v16, v17
    v_cvt_pk_bf16_f32 v16, v16, v16
    v_and_b32 v16, 0xffff0000, v16
    s_add_u32 s36, s28, 14336
    buffer_load_dwordx4 v[224:227], v6, s[16:19], s36 offen
    buffer_load_dwordx4 v[228:231], v6, s[16:19], s36 offen offset:1024
    s_add_u32 s37, s29, 14336
    buffer_load_dwordx4 v[232:235], v6, s[16:19], s37 offen
    buffer_load_dwordx4 v[236:239], v6, s[16:19], s37 offen offset:1024
    v_mfma_f32_32x32x16_bf16 v[136:151], v[88:91], v[60:63], v[136:151]
    v_add_f32 v16, s38, v16
    v_cvt_pk_bf16_f32 v16, v16, v16
    v_and_b32 v16, 0xffff0000, v16
    v_rcp_f32 v16, v16
    ds_read_b128 v[24:27], v7 offset:384
    ds_read_b128 v[28:31], v7 offset:416
    v_mul_f32 v40, v40, v16
    v_mul_f32 v41, v41, v16
    v_mfma_f32_32x32x16_bf16 v[152:167], v[92:95], v[60:63], v[152:167]
    v_cvt_pk_bf16_f32 v64, v40, v41
    v_mul_f32 v42, v42, v16
    v_mul_f32 v43, v43, v16
    v_cvt_pk_bf16_f32 v65, v42, v43
    v_mul_f32 v44, v44, v16
    v_mul_f32 v45, v45, v16
    v_cvt_pk_bf16_f32 v66, v44, v45
    v_mul_f32 v46, v46, v16
    v_mfma_f32_32x32x16_bf16 v[168:183], v[96:99], v[60:63], v[168:183]
    v_mul_f32 v47, v47, v16
    v_cvt_pk_bf16_f32 v67, v46, v47
    v_mul_f32 v48, v48, v16
    v_mul_f32 v49, v49, v16
    v_cvt_pk_bf16_f32 v68, v48, v49
    v_mul_f32 v50, v50, v16
    v_mul_f32 v51, v51, v16
    v_cvt_pk_bf16_f32 v69, v50, v51
    v_mfma_f32_32x32x16_bf16 v[184:199], v[100:103], v[60:63], v[184:199]
    v_mul_f32 v52, v52, v16
    v_mul_f32 v53, v53, v16
    v_cvt_pk_bf16_f32 v70, v52, v53
    v_mul_f32 v54, v54, v16
    v_mul_f32 v55, v55, v16
    v_cvt_pk_bf16_f32 v71, v54, v55
    s_waitcnt lgkmcnt(0)
    s_waitcnt vmcnt(8)
    v_mfma_f32_32x32x16_bf16 v[40:55], v[216:219], v[208:211], 0
    v_mfma_f32_32x32x16_bf16 v[40:55], v[220:223], v[212:215], v[40:55]
    s_barrier
    v_mfma_f32_32x32x16_bf16 v[136:151], v[104:107], v[64:67], v[136:151]
    ds_read_b64_tr_b16 v[72:73], v11 offset:32768
    ds_read_b64_tr_b16 v[74:75], v11 offset:33280
    ds_read_b64_tr_b16 v[76:77], v11 offset:34816
    ds_read_b64_tr_b16 v[78:79], v11 offset:35328
    ds_read_b64_tr_b16 v[80:81], v11 offset:36864
    ds_read_b64_tr_b16 v[82:83], v11 offset:37376
    ds_read_b64_tr_b16 v[84:85], v11 offset:38912
    ds_read_b64_tr_b16 v[86:87], v11 offset:39424
    v_mfma_f32_32x32x16_bf16 v[152:167], v[108:111], v[64:67], v[152:167]
    ds_read_b64_tr_b16 v[88:89], v11 offset:33792
    ds_read_b64_tr_b16 v[90:91], v11 offset:34304
    ds_read_b64_tr_b16 v[92:93], v11 offset:35840
    ds_read_b64_tr_b16 v[94:95], v11 offset:36352
    ds_read_b64_tr_b16 v[96:97], v11 offset:37888
    ds_read_b64_tr_b16 v[98:99], v11 offset:38400
    ds_read_b64_tr_b16 v[100:101], v11 offset:39936
    ds_read_b64_tr_b16 v[102:103], v11 offset:40448
    s_add_u32 m0, s30, 0
    s_mov_b32 s27, 524288
    buffer_load_dwordx4 v2, s[20:23], s27 offen offset:0 lds
    buffer_load_dwordx4 v3, s[20:23], s27 offen offset:1024 lds
    buffer_load_dwordx4 v4, s[20:23], s27 offen offset:2048 lds
    buffer_load_dwordx4 v5, s[20:23], s27 offen offset:3072 lds
    v_mfma_f32_32x32x16_bf16 v[168:183], v[112:115], v[64:67], v[168:183]
    v_dot2_f32_bf16 v16, v208, v24, 0
    v_dot2_f32_bf16 v17, v209, v25, 0
    v_dot2_f32_bf16 v18, v210, v26, 0
    v_dot2_f32_bf16 v19, v211, v27, 0
    v_dot2_f32_bf16 v16, v212, v28, v16
    v_dot2_f32_bf16 v17, v213, v29, v17
    v_dot2_f32_bf16 v18, v214, v30, v18
    v_dot2_f32_bf16 v19, v215, v31, v19
    v_mfma_f32_32x32x16_bf16 v[184:199], v[116:119], v[64:67], v[184:199]
    v_add_f32 v16, v16, v17
    s_nop 0
    v_add_f32 v18, v18, v19
    v_add_f32 v16, v16, v18
    v_mov_b32 v17, v16
    s_nop 1
    v_permlane32_swap_b32 v16, v17
    v_add_f32 v16, v16, v17
    v_cvt_pk_bf16_f32 v16, v16, v16
    v_and_b32 v16, 0xffff0000, v16
    s_add_u32 s36, s28, 16384
    buffer_load_dwordx4 v[240:243], v6, s[16:19], s36 offen
    buffer_load_dwordx4 v[244:247], v6, s[16:19], s36 offen offset:1024
    s_add_u32 s37, s29, 16384
    buffer_load_dwordx4 v[248:251], v6, s[16:19], s37 offen
    buffer_load_dwordx4 v[252:255], v6, s[16:19], s37 offen offset:1024
    v_mfma_f32_32x32x16_bf16 v[136:151], v[120:123], v[68:71], v[136:151]
    v_add_f32 v16, s38, v16
    v_cvt_pk_bf16_f32 v16, v16, v16
    v_and_b32 v16, 0xffff0000, v16
    v_rcp_f32 v16, v16
    ds_read_b128 v[32:35], v7 offset:448
    ds_read_b128 v[36:39], v7 offset:480
    v_mul_f32 v40, v40, v16
    v_mul_f32 v41, v41, v16
    v_mfma_f32_32x32x16_bf16 v[152:167], v[124:127], v[68:71], v[152:167]
    v_cvt_pk_bf16_f32 v56, v40, v41
    v_mul_f32 v42, v42, v16
    v_mul_f32 v43, v43, v16
    v_cvt_pk_bf16_f32 v57, v42, v43
    v_mul_f32 v44, v44, v16
    v_mul_f32 v45, v45, v16
    v_cvt_pk_bf16_f32 v58, v44, v45
    v_mul_f32 v46, v46, v16
    v_mfma_f32_32x32x16_bf16 v[168:183], v[128:131], v[68:71], v[168:183]
    v_mul_f32 v47, v47, v16
    v_cvt_pk_bf16_f32 v59, v46, v47
    v_mul_f32 v48, v48, v16
    v_mul_f32 v49, v49, v16
    v_cvt_pk_bf16_f32 v60, v48, v49
    v_mul_f32 v50, v50, v16
    v_mul_f32 v51, v51, v16
    v_cvt_pk_bf16_f32 v61, v50, v51
    v_mfma_f32_32x32x16_bf16 v[184:199], v[132:135], v[68:71], v[184:199]
    v_mul_f32 v52, v52, v16
    v_mul_f32 v53, v53, v16
    v_cvt_pk_bf16_f32 v62, v52, v53
    v_mul_f32 v54, v54, v16
    v_mul_f32 v55, v55, v16
    v_cvt_pk_bf16_f32 v63, v54, v55
    s_waitcnt lgkmcnt(0)
    s_waitcnt vmcnt(8)
    v_mfma_f32_32x32x16_bf16 v[40:55], v[232:235], v[224:227], 0
    v_mfma_f32_32x32x16_bf16 v[40:55], v[236:239], v[228:231], v[40:55]
    s_barrier
    v_mfma_f32_32x32x16_bf16 v[136:151], v[72:75], v[56:59], v[136:151]
    ds_read_b64_tr_b16 v[104:105], v11 offset:49152
    ds_read_b64_tr_b16 v[106:107], v11 offset:49664
    ds_read_b64_tr_b16 v[108:109], v11 offset:51200
    ds_read_b64_tr_b16 v[110:111], v11 offset:51712
    ds_read_b64_tr_b16 v[112:113], v11 offset:53248
    ds_read_b64_tr_b16 v[114:115], v11 offset:53760
    ds_read_b64_tr_b16 v[116:117], v11 offset:55296
    ds_read_b64_tr_b16 v[118:119], v11 offset:55808
    v_mfma_f32_32x32x16_bf16 v[152:167], v[76:79], v[56:59], v[152:167]
    ds_read_b64_tr_b16 v[120:121], v11 offset:50176
    ds_read_b64_tr_b16 v[122:123], v11 offset:50688
    ds_read_b64_tr_b16 v[124:125], v11 offset:52224
    ds_read_b64_tr_b16 v[126:127], v11 offset:52736
    ds_read_b64_tr_b16 v[128:129], v11 offset:54272
    ds_read_b64_tr_b16 v[130:131], v11 offset:54784
    ds_read_b64_tr_b16 v[132:133], v11 offset:56320
    ds_read_b64_tr_b16 v[134:135], v11 offset:56832
    s_add_u32 m0, s30, 16384
    s_mov_b32 s27, 589824
    buffer_load_dwordx4 v2, s[20:23], s27 offen offset:0 lds
    buffer_load_dwordx4 v3, s[20:23], s27 offen offset:1024 lds
    buffer_load_dwordx4 v4, s[20:23], s27 offen offset:2048 lds
    buffer_load_dwordx4 v5, s[20:23], s27 offen offset:3072 lds
    v_mfma_f32_32x32x16_bf16 v[168:183], v[80:83], v[56:59], v[168:183]
    v_dot2_f32_bf16 v16, v224, v32, 0
    v_dot2_f32_bf16 v17, v225, v33, 0
    v_dot2_f32_bf16 v18, v226, v34, 0
    v_dot2_f32_bf16 v19, v227, v35, 0
    v_dot2_f32_bf16 v16, v228, v36, v16
    v_dot2_f32_bf16 v17, v229, v37, v17
    v_dot2_f32_bf16 v18, v230, v38, v18
    v_dot2_f32_bf16 v19, v231, v39, v19
    v_mfma_f32_32x32x16_bf16 v[184:199], v[84:87], v[56:59], v[184:199]
    v_add_f32 v16, v16, v17
    s_nop 0
    v_add_f32 v18, v18, v19
    v_add_f32 v16, v16, v18
    v_mov_b32 v17, v16
    s_nop 1
    v_permlane32_swap_b32 v16, v17
    v_add_f32 v16, v16, v17
    v_cvt_pk_bf16_f32 v16, v16, v16
    v_and_b32 v16, 0xffff0000, v16
    s_add_u32 s36, s28, 18432
    buffer_load_dwordx4 v[208:211], v6, s[16:19], s36 offen
    buffer_load_dwordx4 v[212:215], v6, s[16:19], s36 offen offset:1024
    s_add_u32 s37, s29, 18432
    buffer_load_dwordx4 v[216:219], v6, s[16:19], s37 offen
    buffer_load_dwordx4 v[220:223], v6, s[16:19], s37 offen offset:1024
    v_mfma_f32_32x32x16_bf16 v[136:151], v[88:91], v[60:63], v[136:151]
    v_add_f32 v16, s38, v16
    v_cvt_pk_bf16_f32 v16, v16, v16
    v_and_b32 v16, 0xffff0000, v16
    v_rcp_f32 v16, v16
    ds_read_b128 v[24:27], v7 offset:512
    ds_read_b128 v[28:31], v7 offset:544
    v_mul_f32 v40, v40, v16
    v_mul_f32 v41, v41, v16
    v_mfma_f32_32x32x16_bf16 v[152:167], v[92:95], v[60:63], v[152:167]
    v_cvt_pk_bf16_f32 v64, v40, v41
    v_mul_f32 v42, v42, v16
    v_mul_f32 v43, v43, v16
    v_cvt_pk_bf16_f32 v65, v42, v43
    v_mul_f32 v44, v44, v16
    v_mul_f32 v45, v45, v16
    v_cvt_pk_bf16_f32 v66, v44, v45
    v_mul_f32 v46, v46, v16
    v_mfma_f32_32x32x16_bf16 v[168:183], v[96:99], v[60:63], v[168:183]
    v_mul_f32 v47, v47, v16
    v_cvt_pk_bf16_f32 v67, v46, v47
    v_mul_f32 v48, v48, v16
    v_mul_f32 v49, v49, v16
    v_cvt_pk_bf16_f32 v68, v48, v49
    v_mul_f32 v50, v50, v16
    v_mul_f32 v51, v51, v16
    v_cvt_pk_bf16_f32 v69, v50, v51
    v_mfma_f32_32x32x16_bf16 v[184:199], v[100:103], v[60:63], v[184:199]
    v_mul_f32 v52, v52, v16
    v_mul_f32 v53, v53, v16
    v_cvt_pk_bf16_f32 v70, v52, v53
    v_mul_f32 v54, v54, v16
    v_mul_f32 v55, v55, v16
    v_cvt_pk_bf16_f32 v71, v54, v55
    s_waitcnt lgkmcnt(0)
    s_waitcnt vmcnt(8)
    v_mfma_f32_32x32x16_bf16 v[40:55], v[248:251], v[240:243], 0
    v_mfma_f32_32x32x16_bf16 v[40:55], v[252:255], v[244:247], v[40:55]
    s_barrier
    v_mfma_f32_32x32x16_bf16 v[136:151], v[104:107], v[64:67], v[136:151]
    ds_read_b64_tr_b16 v[72:73], v11 offset:0
    ds_read_b64_tr_b16 v[74:75], v11 offset:512
    ds_read_b64_tr_b16 v[76:77], v11 offset:2048
    ds_read_b64_tr_b16 v[78:79], v11 offset:2560
    ds_read_b64_tr_b16 v[80:81], v11 offset:4096
    ds_read_b64_tr_b16 v[82:83], v11 offset:4608
    ds_read_b64_tr_b16 v[84:85], v11 offset:6144
    ds_read_b64_tr_b16 v[86:87], v11 offset:6656
    v_mfma_f32_32x32x16_bf16 v[152:167], v[108:111], v[64:67], v[152:167]
    ds_read_b64_tr_b16 v[88:89], v11 offset:1024
    ds_read_b64_tr_b16 v[90:91], v11 offset:1536
    ds_read_b64_tr_b16 v[92:93], v11 offset:3072
    ds_read_b64_tr_b16 v[94:95], v11 offset:3584
    ds_read_b64_tr_b16 v[96:97], v11 offset:5120
    ds_read_b64_tr_b16 v[98:99], v11 offset:5632
    ds_read_b64_tr_b16 v[100:101], v11 offset:7168
    ds_read_b64_tr_b16 v[102:103], v11 offset:7680
    s_add_u32 m0, s30, 32768
    s_mov_b32 s27, 655360
    buffer_load_dwordx4 v2, s[20:23], s27 offen offset:0 lds
    buffer_load_dwordx4 v3, s[20:23], s27 offen offset:1024 lds
    buffer_load_dwordx4 v4, s[20:23], s27 offen offset:2048 lds
    buffer_load_dwordx4 v5, s[20:23], s27 offen offset:3072 lds
    v_mfma_f32_32x32x16_bf16 v[168:183], v[112:115], v[64:67], v[168:183]
    v_dot2_f32_bf16 v16, v240, v24, 0
    v_dot2_f32_bf16 v17, v241, v25, 0
    v_dot2_f32_bf16 v18, v242, v26, 0
    v_dot2_f32_bf16 v19, v243, v27, 0
    v_dot2_f32_bf16 v16, v244, v28, v16
    v_dot2_f32_bf16 v17, v245, v29, v17
    v_dot2_f32_bf16 v18, v246, v30, v18
    v_dot2_f32_bf16 v19, v247, v31, v19
    v_mfma_f32_32x32x16_bf16 v[184:199], v[116:119], v[64:67], v[184:199]
    v_add_f32 v16, v16, v17
    s_nop 0
    v_add_f32 v18, v18, v19
    v_add_f32 v16, v16, v18
    v_mov_b32 v17, v16
    s_nop 1
    v_permlane32_swap_b32 v16, v17
    v_add_f32 v16, v16, v17
    v_cvt_pk_bf16_f32 v16, v16, v16
    v_and_b32 v16, 0xffff0000, v16
    s_add_u32 s36, s28, 20480
    buffer_load_dwordx4 v[224:227], v6, s[16:19], s36 offen
    buffer_load_dwordx4 v[228:231], v6, s[16:19], s36 offen offset:1024
    s_add_u32 s37, s29, 20480
    buffer_load_dwordx4 v[232:235], v6, s[16:19], s37 offen
    buffer_load_dwordx4 v[236:239], v6, s[16:19], s37 offen offset:1024
    v_mfma_f32_32x32x16_bf16 v[136:151], v[120:123], v[68:71], v[136:151]
    v_add_f32 v16, s38, v16
    v_cvt_pk_bf16_f32 v16, v16, v16
    v_and_b32 v16, 0xffff0000, v16
    v_rcp_f32 v16, v16
    ds_read_b128 v[32:35], v7 offset:576
    ds_read_b128 v[36:39], v7 offset:608
    v_mul_f32 v40, v40, v16
    v_mul_f32 v41, v41, v16
    v_mfma_f32_32x32x16_bf16 v[152:167], v[124:127], v[68:71], v[152:167]
    v_cvt_pk_bf16_f32 v56, v40, v41
    v_mul_f32 v42, v42, v16
    v_mul_f32 v43, v43, v16
    v_cvt_pk_bf16_f32 v57, v42, v43
    v_mul_f32 v44, v44, v16
    v_mul_f32 v45, v45, v16
    v_cvt_pk_bf16_f32 v58, v44, v45
    v_mul_f32 v46, v46, v16
    v_mfma_f32_32x32x16_bf16 v[168:183], v[128:131], v[68:71], v[168:183]
    v_mul_f32 v47, v47, v16
    v_cvt_pk_bf16_f32 v59, v46, v47
    v_mul_f32 v48, v48, v16
    v_mul_f32 v49, v49, v16
    v_cvt_pk_bf16_f32 v60, v48, v49
    v_mul_f32 v50, v50, v16
    v_mul_f32 v51, v51, v16
    v_cvt_pk_bf16_f32 v61, v50, v51
    v_mfma_f32_32x32x16_bf16 v[184:199], v[132:135], v[68:71], v[184:199]
    v_mul_f32 v52, v52, v16
    v_mul_f32 v53, v53, v16
    v_cvt_pk_bf16_f32 v62, v52, v53
    v_mul_f32 v54, v54, v16
    v_mul_f32 v55, v55, v16
    v_cvt_pk_bf16_f32 v63, v54, v55
    s_waitcnt lgkmcnt(0)
    s_waitcnt vmcnt(8)
    v_mfma_f32_32x32x16_bf16 v[40:55], v[216:219], v[208:211], 0
    v_mfma_f32_32x32x16_bf16 v[40:55], v[220:223], v[212:215], v[40:55]
    s_barrier
    v_mfma_f32_32x32x16_bf16 v[136:151], v[72:75], v[56:59], v[136:151]
    ds_read_b64_tr_b16 v[104:105], v11 offset:16384
    ds_read_b64_tr_b16 v[106:107], v11 offset:16896
    ds_read_b64_tr_b16 v[108:109], v11 offset:18432
    ds_read_b64_tr_b16 v[110:111], v11 offset:18944
    ds_read_b64_tr_b16 v[112:113], v11 offset:20480
    ds_read_b64_tr_b16 v[114:115], v11 offset:20992
    ds_read_b64_tr_b16 v[116:117], v11 offset:22528
    ds_read_b64_tr_b16 v[118:119], v11 offset:23040
    v_mfma_f32_32x32x16_bf16 v[152:167], v[76:79], v[56:59], v[152:167]
    ds_read_b64_tr_b16 v[120:121], v11 offset:17408
    ds_read_b64_tr_b16 v[122:123], v11 offset:17920
    ds_read_b64_tr_b16 v[124:125], v11 offset:19456
    ds_read_b64_tr_b16 v[126:127], v11 offset:19968
    ds_read_b64_tr_b16 v[128:129], v11 offset:21504
    ds_read_b64_tr_b16 v[130:131], v11 offset:22016
    ds_read_b64_tr_b16 v[132:133], v11 offset:23552
    ds_read_b64_tr_b16 v[134:135], v11 offset:24064
    s_add_u32 m0, s30, 49152
    s_mov_b32 s27, 720896
    buffer_load_dwordx4 v2, s[20:23], s27 offen offset:0 lds
    buffer_load_dwordx4 v3, s[20:23], s27 offen offset:1024 lds
    buffer_load_dwordx4 v4, s[20:23], s27 offen offset:2048 lds
    buffer_load_dwordx4 v5, s[20:23], s27 offen offset:3072 lds
    v_mfma_f32_32x32x16_bf16 v[168:183], v[80:83], v[56:59], v[168:183]
    v_dot2_f32_bf16 v16, v208, v32, 0
    v_dot2_f32_bf16 v17, v209, v33, 0
    v_dot2_f32_bf16 v18, v210, v34, 0
    v_dot2_f32_bf16 v19, v211, v35, 0
    v_dot2_f32_bf16 v16, v212, v36, v16
    v_dot2_f32_bf16 v17, v213, v37, v17
    v_dot2_f32_bf16 v18, v214, v38, v18
    v_dot2_f32_bf16 v19, v215, v39, v19
    v_mfma_f32_32x32x16_bf16 v[184:199], v[84:87], v[56:59], v[184:199]
    v_add_f32 v16, v16, v17
    s_nop 0
    v_add_f32 v18, v18, v19
    v_add_f32 v16, v16, v18
    v_mov_b32 v17, v16
    s_nop 1
    v_permlane32_swap_b32 v16, v17
    v_add_f32 v16, v16, v17
    v_cvt_pk_bf16_f32 v16, v16, v16
    v_and_b32 v16, 0xffff0000, v16
    s_add_u32 s36, s28, 22528
    buffer_load_dwordx4 v[240:243], v6, s[16:19], s36 offen
    buffer_load_dwordx4 v[244:247], v6, s[16:19], s36 offen offset:1024
    s_add_u32 s37, s29, 22528
    buffer_load_dwordx4 v[248:251], v6, s[16:19], s37 offen
    buffer_load_dwordx4 v[252:255], v6, s[16:19], s37 offen offset:1024
    v_mfma_f32_32x32x16_bf16 v[136:151], v[88:91], v[60:63], v[136:151]
    v_add_f32 v16, s38, v16
    v_cvt_pk_bf16_f32 v16, v16, v16
    v_and_b32 v16, 0xffff0000, v16
    v_rcp_f32 v16, v16
    ds_read_b128 v[24:27], v7 offset:640
    ds_read_b128 v[28:31], v7 offset:672
    v_mul_f32 v40, v40, v16
    v_mul_f32 v41, v41, v16
    v_mfma_f32_32x32x16_bf16 v[152:167], v[92:95], v[60:63], v[152:167]
    v_cvt_pk_bf16_f32 v64, v40, v41
    v_mul_f32 v42, v42, v16
    v_mul_f32 v43, v43, v16
    v_cvt_pk_bf16_f32 v65, v42, v43
    v_mul_f32 v44, v44, v16
    v_mul_f32 v45, v45, v16
    v_cvt_pk_bf16_f32 v66, v44, v45
    v_mul_f32 v46, v46, v16
    v_mfma_f32_32x32x16_bf16 v[168:183], v[96:99], v[60:63], v[168:183]
    v_mul_f32 v47, v47, v16
    v_cvt_pk_bf16_f32 v67, v46, v47
    v_mul_f32 v48, v48, v16
    v_mul_f32 v49, v49, v16
    v_cvt_pk_bf16_f32 v68, v48, v49
    v_mul_f32 v50, v50, v16
    v_mul_f32 v51, v51, v16
    v_cvt_pk_bf16_f32 v69, v50, v51
    v_mfma_f32_32x32x16_bf16 v[184:199], v[100:103], v[60:63], v[184:199]
    v_mul_f32 v52, v52, v16
    v_mul_f32 v53, v53, v16
    v_cvt_pk_bf16_f32 v70, v52, v53
    v_mul_f32 v54, v54, v16
    v_mul_f32 v55, v55, v16
    v_cvt_pk_bf16_f32 v71, v54, v55
    s_waitcnt lgkmcnt(0)
    s_waitcnt vmcnt(8)
    v_mfma_f32_32x32x16_bf16 v[40:55], v[232:235], v[224:227], 0
    v_mfma_f32_32x32x16_bf16 v[40:55], v[236:239], v[228:231], v[40:55]
    s_barrier
    v_mfma_f32_32x32x16_bf16 v[136:151], v[104:107], v[64:67], v[136:151]
    ds_read_b64_tr_b16 v[72:73], v11 offset:32768
    ds_read_b64_tr_b16 v[74:75], v11 offset:33280
    ds_read_b64_tr_b16 v[76:77], v11 offset:34816
    ds_read_b64_tr_b16 v[78:79], v11 offset:35328
    ds_read_b64_tr_b16 v[80:81], v11 offset:36864
    ds_read_b64_tr_b16 v[82:83], v11 offset:37376
    ds_read_b64_tr_b16 v[84:85], v11 offset:38912
    ds_read_b64_tr_b16 v[86:87], v11 offset:39424
    v_mfma_f32_32x32x16_bf16 v[152:167], v[108:111], v[64:67], v[152:167]
    ds_read_b64_tr_b16 v[88:89], v11 offset:33792
    ds_read_b64_tr_b16 v[90:91], v11 offset:34304
    ds_read_b64_tr_b16 v[92:93], v11 offset:35840
    ds_read_b64_tr_b16 v[94:95], v11 offset:36352
    ds_read_b64_tr_b16 v[96:97], v11 offset:37888
    ds_read_b64_tr_b16 v[98:99], v11 offset:38400
    ds_read_b64_tr_b16 v[100:101], v11 offset:39936
    ds_read_b64_tr_b16 v[102:103], v11 offset:40448
    s_add_u32 m0, s30, 0
    s_mov_b32 s27, 786432
    buffer_load_dwordx4 v2, s[20:23], s27 offen offset:0 lds
    buffer_load_dwordx4 v3, s[20:23], s27 offen offset:1024 lds
    buffer_load_dwordx4 v4, s[20:23], s27 offen offset:2048 lds
    buffer_load_dwordx4 v5, s[20:23], s27 offen offset:3072 lds
    v_mfma_f32_32x32x16_bf16 v[168:183], v[112:115], v[64:67], v[168:183]
    v_dot2_f32_bf16 v16, v224, v24, 0
    v_dot2_f32_bf16 v17, v225, v25, 0
    v_dot2_f32_bf16 v18, v226, v26, 0
    v_dot2_f32_bf16 v19, v227, v27, 0
    v_dot2_f32_bf16 v16, v228, v28, v16
    v_dot2_f32_bf16 v17, v229, v29, v17
    v_dot2_f32_bf16 v18, v230, v30, v18
    v_dot2_f32_bf16 v19, v231, v31, v19
    v_mfma_f32_32x32x16_bf16 v[184:199], v[116:119], v[64:67], v[184:199]
    v_add_f32 v16, v16, v17
    s_nop 0
    v_add_f32 v18, v18, v19
    v_add_f32 v16, v16, v18
    v_mov_b32 v17, v16
    s_nop 1
    v_permlane32_swap_b32 v16, v17
    v_add_f32 v16, v16, v17
    v_cvt_pk_bf16_f32 v16, v16, v16
    v_and_b32 v16, 0xffff0000, v16
    s_add_u32 s36, s28, 24576
    buffer_load_dwordx4 v[208:211], v6, s[16:19], s36 offen
    buffer_load_dwordx4 v[212:215], v6, s[16:19], s36 offen offset:1024
    s_add_u32 s37, s29, 24576
    buffer_load_dwordx4 v[216:219], v6, s[16:19], s37 offen
    buffer_load_dwordx4 v[220:223], v6, s[16:19], s37 offen offset:1024
    v_mfma_f32_32x32x16_bf16 v[136:151], v[120:123], v[68:71], v[136:151]
    v_add_f32 v16, s38, v16
    v_cvt_pk_bf16_f32 v16, v16, v16
    v_and_b32 v16, 0xffff0000, v16
    v_rcp_f32 v16, v16
    ds_read_b128 v[32:35], v7 offset:704
    ds_read_b128 v[36:39], v7 offset:736
    v_mul_f32 v40, v40, v16
    v_mul_f32 v41, v41, v16
    v_mfma_f32_32x32x16_bf16 v[152:167], v[124:127], v[68:71], v[152:167]
    v_cvt_pk_bf16_f32 v56, v40, v41
    v_mul_f32 v42, v42, v16
    v_mul_f32 v43, v43, v16
    v_cvt_pk_bf16_f32 v57, v42, v43
    v_mul_f32 v44, v44, v16
    v_mul_f32 v45, v45, v16
    v_cvt_pk_bf16_f32 v58, v44, v45
    v_mul_f32 v46, v46, v16
    v_mfma_f32_32x32x16_bf16 v[168:183], v[128:131], v[68:71], v[168:183]
    v_mul_f32 v47, v47, v16
    v_cvt_pk_bf16_f32 v59, v46, v47
    v_mul_f32 v48, v48, v16
    v_mul_f32 v49, v49, v16
    v_cvt_pk_bf16_f32 v60, v48, v49
    v_mul_f32 v50, v50, v16
    v_mul_f32 v51, v51, v16
    v_cvt_pk_bf16_f32 v61, v50, v51
    v_mfma_f32_32x32x16_bf16 v[184:199], v[132:135], v[68:71], v[184:199]
    v_mul_f32 v52, v52, v16
    v_mul_f32 v53, v53, v16
    v_cvt_pk_bf16_f32 v62, v52, v53
    v_mul_f32 v54, v54, v16
    v_mul_f32 v55, v55, v16
    v_cvt_pk_bf16_f32 v63, v54, v55
    s_waitcnt lgkmcnt(0)
    s_waitcnt vmcnt(8)
    v_mfma_f32_32x32x16_bf16 v[40:55], v[248:251], v[240:243], 0
    v_mfma_f32_32x32x16_bf16 v[40:55], v[252:255], v[244:247], v[40:55]
    s_barrier
    v_mfma_f32_32x32x16_bf16 v[136:151], v[72:75], v[56:59], v[136:151]
    ds_read_b64_tr_b16 v[104:105], v11 offset:49152
    ds_read_b64_tr_b16 v[106:107], v11 offset:49664
    ds_read_b64_tr_b16 v[108:109], v11 offset:51200
    ds_read_b64_tr_b16 v[110:111], v11 offset:51712
    ds_read_b64_tr_b16 v[112:113], v11 offset:53248
    ds_read_b64_tr_b16 v[114:115], v11 offset:53760
    ds_read_b64_tr_b16 v[116:117], v11 offset:55296
    ds_read_b64_tr_b16 v[118:119], v11 offset:55808
    v_mfma_f32_32x32x16_bf16 v[152:167], v[76:79], v[56:59], v[152:167]
    ds_read_b64_tr_b16 v[120:121], v11 offset:50176
    ds_read_b64_tr_b16 v[122:123], v11 offset:50688
    ds_read_b64_tr_b16 v[124:125], v11 offset:52224
    ds_read_b64_tr_b16 v[126:127], v11 offset:52736
    ds_read_b64_tr_b16 v[128:129], v11 offset:54272
    ds_read_b64_tr_b16 v[130:131], v11 offset:54784
    ds_read_b64_tr_b16 v[132:133], v11 offset:56320
    ds_read_b64_tr_b16 v[134:135], v11 offset:56832
    s_add_u32 m0, s30, 16384
    s_mov_b32 s27, 851968
    buffer_load_dwordx4 v2, s[20:23], s27 offen offset:0 lds
    buffer_load_dwordx4 v3, s[20:23], s27 offen offset:1024 lds
    buffer_load_dwordx4 v4, s[20:23], s27 offen offset:2048 lds
    buffer_load_dwordx4 v5, s[20:23], s27 offen offset:3072 lds
    v_mfma_f32_32x32x16_bf16 v[168:183], v[80:83], v[56:59], v[168:183]
    v_dot2_f32_bf16 v16, v240, v32, 0
    v_dot2_f32_bf16 v17, v241, v33, 0
    v_dot2_f32_bf16 v18, v242, v34, 0
    v_dot2_f32_bf16 v19, v243, v35, 0
    v_dot2_f32_bf16 v16, v244, v36, v16
    v_dot2_f32_bf16 v17, v245, v37, v17
    v_dot2_f32_bf16 v18, v246, v38, v18
    v_dot2_f32_bf16 v19, v247, v39, v19
    v_mfma_f32_32x32x16_bf16 v[184:199], v[84:87], v[56:59], v[184:199]
    v_add_f32 v16, v16, v17
    s_nop 0
    v_add_f32 v18, v18, v19
    v_add_f32 v16, v16, v18
    v_mov_b32 v17, v16
    s_nop 1
    v_permlane32_swap_b32 v16, v17
    v_add_f32 v16, v16, v17
    v_cvt_pk_bf16_f32 v16, v16, v16
    v_and_b32 v16, 0xffff0000, v16
    s_add_u32 s36, s28, 26624
    buffer_load_dwordx4 v[224:227], v6, s[16:19], s36 offen
    buffer_load_dwordx4 v[228:231], v6, s[16:19], s36 offen offset:1024
    s_add_u32 s37, s29, 26624
    buffer_load_dwordx4 v[232:235], v6, s[16:19], s37 offen
    buffer_load_dwordx4 v[236:239], v6, s[16:19], s37 offen offset:1024
    v_mfma_f32_32x32x16_bf16 v[136:151], v[88:91], v[60:63], v[136:151]
    v_add_f32 v16, s38, v16
    v_cvt_pk_bf16_f32 v16, v16, v16
    v_and_b32 v16, 0xffff0000, v16
    v_rcp_f32 v16, v16
    ds_read_b128 v[24:27], v7 offset:768
    ds_read_b128 v[28:31], v7 offset:800
    v_mul_f32 v40, v40, v16
    v_mul_f32 v41, v41, v16
    v_mfma_f32_32x32x16_bf16 v[152:167], v[92:95], v[60:63], v[152:167]
    v_cvt_pk_bf16_f32 v64, v40, v41
    v_mul_f32 v42, v42, v16
    v_mul_f32 v43, v43, v16
    v_cvt_pk_bf16_f32 v65, v42, v43
    v_mul_f32 v44, v44, v16
    v_mul_f32 v45, v45, v16
    v_cvt_pk_bf16_f32 v66, v44, v45
    v_mul_f32 v46, v46, v16
    v_mfma_f32_32x32x16_bf16 v[168:183], v[96:99], v[60:63], v[168:183]
    v_mul_f32 v47, v47, v16
    v_cvt_pk_bf16_f32 v67, v46, v47
    v_mul_f32 v48, v48, v16
    v_mul_f32 v49, v49, v16
    v_cvt_pk_bf16_f32 v68, v48, v49
    v_mul_f32 v50, v50, v16
    v_mul_f32 v51, v51, v16
    v_cvt_pk_bf16_f32 v69, v50, v51
    v_mfma_f32_32x32x16_bf16 v[184:199], v[100:103], v[60:63], v[184:199]
    v_mul_f32 v52, v52, v16
    v_mul_f32 v53, v53, v16
    v_cvt_pk_bf16_f32 v70, v52, v53
    v_mul_f32 v54, v54, v16
    v_mul_f32 v55, v55, v16
    v_cvt_pk_bf16_f32 v71, v54, v55
    s_waitcnt lgkmcnt(0)
    s_waitcnt vmcnt(8)
    v_mfma_f32_32x32x16_bf16 v[40:55], v[216:219], v[208:211], 0
    v_mfma_f32_32x32x16_bf16 v[40:55], v[220:223], v[212:215], v[40:55]
    s_barrier
    v_mfma_f32_32x32x16_bf16 v[136:151], v[104:107], v[64:67], v[136:151]
    ds_read_b64_tr_b16 v[72:73], v11 offset:0
    ds_read_b64_tr_b16 v[74:75], v11 offset:512
    ds_read_b64_tr_b16 v[76:77], v11 offset:2048
    ds_read_b64_tr_b16 v[78:79], v11 offset:2560
    ds_read_b64_tr_b16 v[80:81], v11 offset:4096
    ds_read_b64_tr_b16 v[82:83], v11 offset:4608
    ds_read_b64_tr_b16 v[84:85], v11 offset:6144
    ds_read_b64_tr_b16 v[86:87], v11 offset:6656
    v_mfma_f32_32x32x16_bf16 v[152:167], v[108:111], v[64:67], v[152:167]
    ds_read_b64_tr_b16 v[88:89], v11 offset:1024
    ds_read_b64_tr_b16 v[90:91], v11 offset:1536
    ds_read_b64_tr_b16 v[92:93], v11 offset:3072
    ds_read_b64_tr_b16 v[94:95], v11 offset:3584
    ds_read_b64_tr_b16 v[96:97], v11 offset:5120
    ds_read_b64_tr_b16 v[98:99], v11 offset:5632
    ds_read_b64_tr_b16 v[100:101], v11 offset:7168
    ds_read_b64_tr_b16 v[102:103], v11 offset:7680
    s_add_u32 m0, s30, 32768
    s_mov_b32 s27, 917504
    buffer_load_dwordx4 v2, s[20:23], s27 offen offset:0 lds
    buffer_load_dwordx4 v3, s[20:23], s27 offen offset:1024 lds
    buffer_load_dwordx4 v4, s[20:23], s27 offen offset:2048 lds
    buffer_load_dwordx4 v5, s[20:23], s27 offen offset:3072 lds
    v_mfma_f32_32x32x16_bf16 v[168:183], v[112:115], v[64:67], v[168:183]
    v_dot2_f32_bf16 v16, v208, v24, 0
    v_dot2_f32_bf16 v17, v209, v25, 0
    v_dot2_f32_bf16 v18, v210, v26, 0
    v_dot2_f32_bf16 v19, v211, v27, 0
    v_dot2_f32_bf16 v16, v212, v28, v16
    v_dot2_f32_bf16 v17, v213, v29, v17
    v_dot2_f32_bf16 v18, v214, v30, v18
    v_dot2_f32_bf16 v19, v215, v31, v19
    v_mfma_f32_32x32x16_bf16 v[184:199], v[116:119], v[64:67], v[184:199]
    v_add_f32 v16, v16, v17
    s_nop 0
    v_add_f32 v18, v18, v19
    v_add_f32 v16, v16, v18
    v_mov_b32 v17, v16
    s_nop 1
    v_permlane32_swap_b32 v16, v17
    v_add_f32 v16, v16, v17
    v_cvt_pk_bf16_f32 v16, v16, v16
    v_and_b32 v16, 0xffff0000, v16
    s_add_u32 s36, s28, 28672
    buffer_load_dwordx4 v[240:243], v6, s[16:19], s36 offen
    buffer_load_dwordx4 v[244:247], v6, s[16:19], s36 offen offset:1024
    s_add_u32 s37, s29, 28672
    buffer_load_dwordx4 v[248:251], v6, s[16:19], s37 offen
    buffer_load_dwordx4 v[252:255], v6, s[16:19], s37 offen offset:1024
    v_mfma_f32_32x32x16_bf16 v[136:151], v[120:123], v[68:71], v[136:151]
    v_add_f32 v16, s38, v16
    v_cvt_pk_bf16_f32 v16, v16, v16
    v_and_b32 v16, 0xffff0000, v16
    v_rcp_f32 v16, v16
    ds_read_b128 v[32:35], v7 offset:832
    ds_read_b128 v[36:39], v7 offset:864
    v_mul_f32 v40, v40, v16
    v_mul_f32 v41, v41, v16
    v_mfma_f32_32x32x16_bf16 v[152:167], v[124:127], v[68:71], v[152:167]
    v_cvt_pk_bf16_f32 v56, v40, v41
    v_mul_f32 v42, v42, v16
    v_mul_f32 v43, v43, v16
    v_cvt_pk_bf16_f32 v57, v42, v43
    v_mul_f32 v44, v44, v16
    v_mul_f32 v45, v45, v16
    v_cvt_pk_bf16_f32 v58, v44, v45
    v_mul_f32 v46, v46, v16
    v_mfma_f32_32x32x16_bf16 v[168:183], v[128:131], v[68:71], v[168:183]
    v_mul_f32 v47, v47, v16
    v_cvt_pk_bf16_f32 v59, v46, v47
    v_mul_f32 v48, v48, v16
    v_mul_f32 v49, v49, v16
    v_cvt_pk_bf16_f32 v60, v48, v49
    v_mul_f32 v50, v50, v16
    v_mul_f32 v51, v51, v16
    v_cvt_pk_bf16_f32 v61, v50, v51
    v_mfma_f32_32x32x16_bf16 v[184:199], v[132:135], v[68:71], v[184:199]
    v_mul_f32 v52, v52, v16
    v_mul_f32 v53, v53, v16
    v_cvt_pk_bf16_f32 v62, v52, v53
    v_mul_f32 v54, v54, v16
    v_mul_f32 v55, v55, v16
    v_cvt_pk_bf16_f32 v63, v54, v55
    s_waitcnt lgkmcnt(0)
    s_waitcnt vmcnt(8)
    v_mfma_f32_32x32x16_bf16 v[40:55], v[232:235], v[224:227], 0
    v_mfma_f32_32x32x16_bf16 v[40:55], v[236:239], v[228:231], v[40:55]
    s_barrier
    v_mfma_f32_32x32x16_bf16 v[136:151], v[72:75], v[56:59], v[136:151]
    ds_read_b64_tr_b16 v[104:105], v11 offset:16384
    ds_read_b64_tr_b16 v[106:107], v11 offset:16896
    ds_read_b64_tr_b16 v[108:109], v11 offset:18432
    ds_read_b64_tr_b16 v[110:111], v11 offset:18944
    ds_read_b64_tr_b16 v[112:113], v11 offset:20480
    ds_read_b64_tr_b16 v[114:115], v11 offset:20992
    ds_read_b64_tr_b16 v[116:117], v11 offset:22528
    ds_read_b64_tr_b16 v[118:119], v11 offset:23040
    v_mfma_f32_32x32x16_bf16 v[152:167], v[76:79], v[56:59], v[152:167]
    ds_read_b64_tr_b16 v[120:121], v11 offset:17408
    ds_read_b64_tr_b16 v[122:123], v11 offset:17920
    ds_read_b64_tr_b16 v[124:125], v11 offset:19456
    ds_read_b64_tr_b16 v[126:127], v11 offset:19968
    ds_read_b64_tr_b16 v[128:129], v11 offset:21504
    ds_read_b64_tr_b16 v[130:131], v11 offset:22016
    ds_read_b64_tr_b16 v[132:133], v11 offset:23552
    ds_read_b64_tr_b16 v[134:135], v11 offset:24064
    s_add_u32 m0, s30, 49152
    s_mov_b32 s27, 983040
    buffer_load_dwordx4 v2, s[20:23], s27 offen offset:0 lds
    buffer_load_dwordx4 v3, s[20:23], s27 offen offset:1024 lds
    buffer_load_dwordx4 v4, s[20:23], s27 offen offset:2048 lds
    buffer_load_dwordx4 v5, s[20:23], s27 offen offset:3072 lds
    v_mfma_f32_32x32x16_bf16 v[168:183], v[80:83], v[56:59], v[168:183]
    v_dot2_f32_bf16 v16, v224, v32, 0
    v_dot2_f32_bf16 v17, v225, v33, 0
    v_dot2_f32_bf16 v18, v226, v34, 0
    v_dot2_f32_bf16 v19, v227, v35, 0
    v_dot2_f32_bf16 v16, v228, v36, v16
    v_dot2_f32_bf16 v17, v229, v37, v17
    v_dot2_f32_bf16 v18, v230, v38, v18
    v_dot2_f32_bf16 v19, v231, v39, v19
    v_mfma_f32_32x32x16_bf16 v[184:199], v[84:87], v[56:59], v[184:199]
    v_add_f32 v16, v16, v17
    s_nop 0
    v_add_f32 v18, v18, v19
    v_add_f32 v16, v16, v18
    v_mov_b32 v17, v16
    s_nop 1
    v_permlane32_swap_b32 v16, v17
    v_add_f32 v16, v16, v17
    v_cvt_pk_bf16_f32 v16, v16, v16
    v_and_b32 v16, 0xffff0000, v16
    s_add_u32 s36, s28, 30720
    buffer_load_dwordx4 v[208:211], v6, s[16:19], s36 offen
    buffer_load_dwordx4 v[212:215], v6, s[16:19], s36 offen offset:1024
    s_add_u32 s37, s29, 30720
    buffer_load_dwordx4 v[216:219], v6, s[16:19], s37 offen
    buffer_load_dwordx4 v[220:223], v6, s[16:19], s37 offen offset:1024
    v_mfma_f32_32x32x16_bf16 v[136:151], v[88:91], v[60:63], v[136:151]
    v_add_f32 v16, s38, v16
    v_cvt_pk_bf16_f32 v16, v16, v16
    v_and_b32 v16, 0xffff0000, v16
    v_rcp_f32 v16, v16
    ds_read_b128 v[24:27], v7 offset:896
    ds_read_b128 v[28:31], v7 offset:928
    v_mul_f32 v40, v40, v16
    v_mul_f32 v41, v41, v16
    v_mfma_f32_32x32x16_bf16 v[152:167], v[92:95], v[60:63], v[152:167]
    v_cvt_pk_bf16_f32 v64, v40, v41
    v_mul_f32 v42, v42, v16
    v_mul_f32 v43, v43, v16
    v_cvt_pk_bf16_f32 v65, v42, v43
    v_mul_f32 v44, v44, v16
    v_mul_f32 v45, v45, v16
    v_cvt_pk_bf16_f32 v66, v44, v45
    v_mul_f32 v46, v46, v16
    v_mfma_f32_32x32x16_bf16 v[168:183], v[96:99], v[60:63], v[168:183]
    v_mul_f32 v47, v47, v16
    v_cvt_pk_bf16_f32 v67, v46, v47
    v_mul_f32 v48, v48, v16
    v_mul_f32 v49, v49, v16
    v_cvt_pk_bf16_f32 v68, v48, v49
    v_mul_f32 v50, v50, v16
    v_mul_f32 v51, v51, v16
    v_cvt_pk_bf16_f32 v69, v50, v51
    v_mfma_f32_32x32x16_bf16 v[184:199], v[100:103], v[60:63], v[184:199]
    v_mul_f32 v52, v52, v16
    v_mul_f32 v53, v53, v16
    v_cvt_pk_bf16_f32 v70, v52, v53
    v_mul_f32 v54, v54, v16
    v_mul_f32 v55, v55, v16
    v_cvt_pk_bf16_f32 v71, v54, v55
    s_waitcnt lgkmcnt(0)
    s_waitcnt vmcnt(8)
    v_mfma_f32_32x32x16_bf16 v[40:55], v[248:251], v[240:243], 0
    v_mfma_f32_32x32x16_bf16 v[40:55], v[252:255], v[244:247], v[40:55]
    s_barrier
    v_mfma_f32_32x32x16_bf16 v[136:151], v[104:107], v[64:67], v[136:151]
    ds_read_b64_tr_b16 v[72:73], v11 offset:32768
    ds_read_b64_tr_b16 v[74:75], v11 offset:33280
    ds_read_b64_tr_b16 v[76:77], v11 offset:34816
    ds_read_b64_tr_b16 v[78:79], v11 offset:35328
    ds_read_b64_tr_b16 v[80:81], v11 offset:36864
    ds_read_b64_tr_b16 v[82:83], v11 offset:37376
    ds_read_b64_tr_b16 v[84:85], v11 offset:38912
    ds_read_b64_tr_b16 v[86:87], v11 offset:39424
    v_mfma_f32_32x32x16_bf16 v[152:167], v[108:111], v[64:67], v[152:167]
    ds_read_b64_tr_b16 v[88:89], v11 offset:33792
    ds_read_b64_tr_b16 v[90:91], v11 offset:34304
    ds_read_b64_tr_b16 v[92:93], v11 offset:35840
    ds_read_b64_tr_b16 v[94:95], v11 offset:36352
    ds_read_b64_tr_b16 v[96:97], v11 offset:37888
    ds_read_b64_tr_b16 v[98:99], v11 offset:38400
    ds_read_b64_tr_b16 v[100:101], v11 offset:39936
    ds_read_b64_tr_b16 v[102:103], v11 offset:40448
    v_mfma_f32_32x32x16_bf16 v[168:183], v[112:115], v[64:67], v[168:183]
    v_dot2_f32_bf16 v16, v240, v24, 0
    v_dot2_f32_bf16 v17, v241, v25, 0
    v_dot2_f32_bf16 v18, v242, v26, 0
    v_dot2_f32_bf16 v19, v243, v27, 0
    v_dot2_f32_bf16 v16, v244, v28, v16
    v_dot2_f32_bf16 v17, v245, v29, v17
    v_dot2_f32_bf16 v18, v246, v30, v18
    v_dot2_f32_bf16 v19, v247, v31, v19
    v_mfma_f32_32x32x16_bf16 v[184:199], v[116:119], v[64:67], v[184:199]
    v_add_f32 v16, v16, v17
    s_nop 0
    v_add_f32 v18, v18, v19
    v_add_f32 v16, v16, v18
    v_mov_b32 v17, v16
    s_nop 1
    v_permlane32_swap_b32 v16, v17
    v_add_f32 v16, v16, v17
    v_cvt_pk_bf16_f32 v16, v16, v16
    v_and_b32 v16, 0xffff0000, v16
    v_mfma_f32_32x32x16_bf16 v[136:151], v[120:123], v[68:71], v[136:151]
    v_add_f32 v16, s38, v16
    v_cvt_pk_bf16_f32 v16, v16, v16
    v_and_b32 v16, 0xffff0000, v16
    v_rcp_f32 v16, v16
    ds_read_b128 v[32:35], v7 offset:960
    ds_read_b128 v[36:39], v7 offset:992
    v_mul_f32 v40, v40, v16
    v_mul_f32 v41, v41, v16
    v_mfma_f32_32x32x16_bf16 v[152:167], v[124:127], v[68:71], v[152:167]
    v_cvt_pk_bf16_f32 v56, v40, v41
    v_mul_f32 v42, v42, v16
    v_mul_f32 v43, v43, v16
    v_cvt_pk_bf16_f32 v57, v42, v43
    v_mul_f32 v44, v44, v16
    v_mul_f32 v45, v45, v16
    v_cvt_pk_bf16_f32 v58, v44, v45
    v_mul_f32 v46, v46, v16
    v_mfma_f32_32x32x16_bf16 v[168:183], v[128:131], v[68:71], v[168:183]
    v_mul_f32 v47, v47, v16
    v_cvt_pk_bf16_f32 v59, v46, v47
    v_mul_f32 v48, v48, v16
    v_mul_f32 v49, v49, v16
    v_cvt_pk_bf16_f32 v60, v48, v49
    v_mul_f32 v50, v50, v16
    v_mul_f32 v51, v51, v16
    v_cvt_pk_bf16_f32 v61, v50, v51
    v_mfma_f32_32x32x16_bf16 v[184:199], v[132:135], v[68:71], v[184:199]
    v_mul_f32 v52, v52, v16
    v_mul_f32 v53, v53, v16
    v_cvt_pk_bf16_f32 v62, v52, v53
    v_mul_f32 v54, v54, v16
    v_mul_f32 v55, v55, v16
    v_cvt_pk_bf16_f32 v63, v54, v55
    s_waitcnt lgkmcnt(0)
    s_waitcnt vmcnt(0)
    v_mfma_f32_32x32x16_bf16 v[40:55], v[216:219], v[208:211], 0
    v_mfma_f32_32x32x16_bf16 v[40:55], v[220:223], v[212:215], v[40:55]
    s_barrier
    v_mfma_f32_32x32x16_bf16 v[136:151], v[72:75], v[56:59], v[136:151]
    ds_read_b64_tr_b16 v[104:105], v11 offset:49152
    ds_read_b64_tr_b16 v[106:107], v11 offset:49664
    ds_read_b64_tr_b16 v[108:109], v11 offset:51200
    ds_read_b64_tr_b16 v[110:111], v11 offset:51712
    ds_read_b64_tr_b16 v[112:113], v11 offset:53248
    ds_read_b64_tr_b16 v[114:115], v11 offset:53760
    ds_read_b64_tr_b16 v[116:117], v11 offset:55296
    ds_read_b64_tr_b16 v[118:119], v11 offset:55808
    v_mfma_f32_32x32x16_bf16 v[152:167], v[76:79], v[56:59], v[152:167]
    ds_read_b64_tr_b16 v[120:121], v11 offset:50176
    ds_read_b64_tr_b16 v[122:123], v11 offset:50688
    ds_read_b64_tr_b16 v[124:125], v11 offset:52224
    ds_read_b64_tr_b16 v[126:127], v11 offset:52736
    ds_read_b64_tr_b16 v[128:129], v11 offset:54272
    ds_read_b64_tr_b16 v[130:131], v11 offset:54784
    ds_read_b64_tr_b16 v[132:133], v11 offset:56320
    ds_read_b64_tr_b16 v[134:135], v11 offset:56832
    v_mfma_f32_32x32x16_bf16 v[168:183], v[80:83], v[56:59], v[168:183]
    v_dot2_f32_bf16 v16, v208, v32, 0
    v_dot2_f32_bf16 v17, v209, v33, 0
    v_dot2_f32_bf16 v18, v210, v34, 0
    v_dot2_f32_bf16 v19, v211, v35, 0
    v_dot2_f32_bf16 v16, v212, v36, v16
    v_dot2_f32_bf16 v17, v213, v37, v17
    v_dot2_f32_bf16 v18, v214, v38, v18
    v_dot2_f32_bf16 v19, v215, v39, v19
    v_mfma_f32_32x32x16_bf16 v[184:199], v[84:87], v[56:59], v[184:199]
    v_add_f32 v16, v16, v17
    s_nop 0
    v_add_f32 v18, v18, v19
    v_add_f32 v16, v16, v18
    v_mov_b32 v17, v16
    s_nop 1
    v_permlane32_swap_b32 v16, v17
    v_add_f32 v16, v16, v17
    v_cvt_pk_bf16_f32 v16, v16, v16
    v_and_b32 v16, 0xffff0000, v16
    v_mfma_f32_32x32x16_bf16 v[136:151], v[88:91], v[60:63], v[136:151]
    v_add_f32 v16, s38, v16
    v_cvt_pk_bf16_f32 v16, v16, v16
    v_and_b32 v16, 0xffff0000, v16
    v_rcp_f32 v16, v16
    s_nop 0
    v_mul_f32 v40, v40, v16
    v_mul_f32 v41, v41, v16
    v_cvt_pk_bf16_f32 v64, v40, v41
    v_mul_f32 v42, v42, v16
    v_mfma_f32_32x32x16_bf16 v[152:167], v[92:95], v[60:63], v[152:167]
    v_mul_f32 v43, v43, v16
    v_cvt_pk_bf16_f32 v65, v42, v43
    v_mul_f32 v44, v44, v16
    v_mul_f32 v45, v45, v16
    v_cvt_pk_bf16_f32 v66, v44, v45
    v_mul_f32 v46, v46, v16
    v_mul_f32 v47, v47, v16
    v_cvt_pk_bf16_f32 v67, v46, v47
    v_mfma_f32_32x32x16_bf16 v[168:183], v[96:99], v[60:63], v[168:183]
    v_mul_f32 v48, v48, v16
    v_mul_f32 v49, v49, v16
    v_cvt_pk_bf16_f32 v68, v48, v49
    v_mul_f32 v50, v50, v16
    v_mul_f32 v51, v51, v16
    v_cvt_pk_bf16_f32 v69, v50, v51
    v_mul_f32 v52, v52, v16
    v_mul_f32 v53, v53, v16
    v_mfma_f32_32x32x16_bf16 v[184:199], v[100:103], v[60:63], v[184:199]
    v_cvt_pk_bf16_f32 v70, v52, v53
    v_mul_f32 v54, v54, v16
    v_mul_f32 v55, v55, v16
    v_cvt_pk_bf16_f32 v71, v54, v55
    s_waitcnt lgkmcnt(0)
    v_mfma_f32_32x32x16_bf16 v[136:151], v[104:107], v[64:67], v[136:151]
    v_mfma_f32_32x32x16_bf16 v[152:167], v[108:111], v[64:67], v[152:167]
    v_mfma_f32_32x32x16_bf16 v[168:183], v[112:115], v[64:67], v[168:183]
    v_mfma_f32_32x32x16_bf16 v[184:199], v[116:119], v[64:67], v[184:199]
    v_mfma_f32_32x32x16_bf16 v[136:151], v[120:123], v[68:71], v[136:151]
    v_mfma_f32_32x32x16_bf16 v[152:167], v[124:127], v[68:71], v[152:167]
    v_mfma_f32_32x32x16_bf16 v[168:183], v[128:131], v[68:71], v[168:183]
    v_mfma_f32_32x32x16_bf16 v[184:199], v[132:135], v[68:71], v[184:199]
    s_barrier
    s_lshl_b32 s32, s40, 14
    v_add_u32 v13, s32, v6
    s_cmp_eq_u32 s41, 0
    s_cbranch_scc1 L_kh0_7
    s_nop 3
    ds_write_b128 v13, v[136:139] offset:0
    ds_write_b128 v13, v[140:143] offset:1024
    ds_write_b128 v13, v[144:147] offset:2048
    ds_write_b128 v13, v[148:151] offset:3072
    ds_write_b128 v13, v[152:155] offset:4096
    ds_write_b128 v13, v[156:159] offset:5120
    ds_write_b128 v13, v[160:163] offset:6144
    ds_write_b128 v13, v[164:167] offset:7168
    ds_write_b128 v13, v[168:171] offset:8192
    ds_write_b128 v13, v[172:175] offset:9216
    ds_write_b128 v13, v[176:179] offset:10240
    ds_write_b128 v13, v[180:183] offset:11264
    ds_write_b128 v13, v[184:187] offset:12288
    ds_write_b128 v13, v[188:191] offset:13312
    ds_write_b128 v13, v[192:195] offset:14336
    ds_write_b128 v13, v[196:199] offset:15360
    s_waitcnt lgkmcnt(0)
    s_barrier
    s_branch L_k2_exit
    s_nop 0
L_kh0_7:
    s_barrier
    ds_read_b128 v[40:43], v13 offset:0
    ds_read_b128 v[44:47], v13 offset:1024
    ds_read_b128 v[48:51], v13 offset:2048
    ds_read_b128 v[52:55], v13 offset:3072
    ds_read_b128 v[56:59], v13 offset:4096
    ds_read_b128 v[60:63], v13 offset:5120
    ds_read_b128 v[64:67], v13 offset:6144
    ds_read_b128 v[68:71], v13 offset:7168
    ds_read_b128 v[72:75], v13 offset:8192
    ds_read_b128 v[76:79], v13 offset:9216
    ds_read_b128 v[80:83], v13 offset:10240
    ds_read_b128 v[84:87], v13 offset:11264
    ds_read_b128 v[88:91], v13 offset:12288
    ds_read_b128 v[92:95], v13 offset:13312
    ds_read_b128 v[96:99], v13 offset:14336
    ds_read_b128 v[100:103], v13 offset:15360
    s_lshl_b32 s32, s25, 1
    s_add_u32 s32, s32, s40
    s_lshl_b32 s32, s32, 17
    s_lshl_b32 s33, s26, 8
    s_add_u32 s32, s32, s33
    v_and_b32 v12, 31, v1
    v_lshlrev_b32 v12, 12, v12
    v_lshrrev_b32 v13, 5, v1
    v_lshl_add_u32 v12, v13, 4, v12
    s_waitcnt lgkmcnt(0)
    v_add_f32 v136, v136, v40
    v_add_f32 v137, v137, v41
    v_add_f32 v138, v138, v42
    v_add_f32 v139, v139, v43
    v_add_f32 v140, v140, v44
    v_add_f32 v141, v141, v45
    v_add_f32 v142, v142, v46
    v_add_f32 v143, v143, v47
    v_add_f32 v144, v144, v48
    v_add_f32 v145, v145, v49
    v_add_f32 v146, v146, v50
    v_add_f32 v147, v147, v51
    v_add_f32 v148, v148, v52
    v_add_f32 v149, v149, v53
    v_add_f32 v150, v150, v54
    v_add_f32 v151, v151, v55
    v_add_f32 v152, v152, v56
    v_add_f32 v153, v153, v57
    v_add_f32 v154, v154, v58
    v_add_f32 v155, v155, v59
    v_add_f32 v156, v156, v60
    v_add_f32 v157, v157, v61
    v_add_f32 v158, v158, v62
    v_add_f32 v159, v159, v63
    v_add_f32 v160, v160, v64
    v_add_f32 v161, v161, v65
    v_add_f32 v162, v162, v66
    v_add_f32 v163, v163, v67
    v_add_f32 v164, v164, v68
    v_add_f32 v165, v165, v69
    v_add_f32 v166, v166, v70
    v_add_f32 v167, v167, v71
    v_add_f32 v168, v168, v72
    v_add_f32 v169, v169, v73
    v_add_f32 v170, v170, v74
    v_add_f32 v171, v171, v75
    v_add_f32 v172, v172, v76
    v_add_f32 v173, v173, v77
    v_add_f32 v174, v174, v78
    v_add_f32 v175, v175, v79
    v_add_f32 v176, v176, v80
    v_add_f32 v177, v177, v81
    v_add_f32 v178, v178, v82
    v_add_f32 v179, v179, v83
    v_add_f32 v180, v180, v84
    v_add_f32 v181, v181, v85
    v_add_f32 v182, v182, v86
    v_add_f32 v183, v183, v87
    v_add_f32 v184, v184, v88
    v_add_f32 v185, v185, v89
    v_add_f32 v186, v186, v90
    v_add_f32 v187, v187, v91
    v_add_f32 v188, v188, v92
    v_add_f32 v189, v189, v93
    v_add_f32 v190, v190, v94
    v_add_f32 v191, v191, v95
    v_add_f32 v192, v192, v96
    v_add_f32 v193, v193, v97
    v_add_f32 v194, v194, v98
    v_add_f32 v195, v195, v99
    v_add_f32 v196, v196, v100
    v_add_f32 v197, v197, v101
    v_add_f32 v198, v198, v102
    v_add_f32 v199, v199, v103
    v_cvt_pk_bf16_f32 v40, v136, v137
    v_cvt_pk_bf16_f32 v41, v138, v139
    v_cvt_pk_bf16_f32 v42, v140, v141
    v_cvt_pk_bf16_f32 v43, v142, v143
    s_nop 0
    v_permlane32_swap_b32 v40, v42
    v_permlane32_swap_b32 v41, v43
    buffer_store_dwordx4 v[40:43], v12, s[12:15], s32 offen offset:0
    v_cvt_pk_bf16_f32 v44, v144, v145
    v_cvt_pk_bf16_f32 v45, v146, v147
    v_cvt_pk_bf16_f32 v46, v148, v149
    v_cvt_pk_bf16_f32 v47, v150, v151
    s_nop 0
    v_permlane32_swap_b32 v44, v46
    v_permlane32_swap_b32 v45, v47
    buffer_store_dwordx4 v[44:47], v12, s[12:15], s32 offen offset:32
    v_cvt_pk_bf16_f32 v48, v152, v153
    v_cvt_pk_bf16_f32 v49, v154, v155
    v_cvt_pk_bf16_f32 v50, v156, v157
    v_cvt_pk_bf16_f32 v51, v158, v159
    s_nop 0
    v_permlane32_swap_b32 v48, v50
    v_permlane32_swap_b32 v49, v51
    buffer_store_dwordx4 v[48:51], v12, s[12:15], s32 offen offset:64
    v_cvt_pk_bf16_f32 v52, v160, v161
    v_cvt_pk_bf16_f32 v53, v162, v163
    v_cvt_pk_bf16_f32 v54, v164, v165
    v_cvt_pk_bf16_f32 v55, v166, v167
    s_nop 0
    v_permlane32_swap_b32 v52, v54
    v_permlane32_swap_b32 v53, v55
    buffer_store_dwordx4 v[52:55], v12, s[12:15], s32 offen offset:96
    v_cvt_pk_bf16_f32 v56, v168, v169
    v_cvt_pk_bf16_f32 v57, v170, v171
    v_cvt_pk_bf16_f32 v58, v172, v173
    v_cvt_pk_bf16_f32 v59, v174, v175
    s_nop 0
    v_permlane32_swap_b32 v56, v58
    v_permlane32_swap_b32 v57, v59
    buffer_store_dwordx4 v[56:59], v12, s[12:15], s32 offen offset:128
    v_cvt_pk_bf16_f32 v60, v176, v177
    v_cvt_pk_bf16_f32 v61, v178, v179
    v_cvt_pk_bf16_f32 v62, v180, v181
    v_cvt_pk_bf16_f32 v63, v182, v183
    s_nop 0
    v_permlane32_swap_b32 v60, v62
    v_permlane32_swap_b32 v61, v63
    buffer_store_dwordx4 v[60:63], v12, s[12:15], s32 offen offset:160
    v_cvt_pk_bf16_f32 v64, v184, v185
    v_cvt_pk_bf16_f32 v65, v186, v187
    v_cvt_pk_bf16_f32 v66, v188, v189
    v_cvt_pk_bf16_f32 v67, v190, v191
    s_nop 0
    v_permlane32_swap_b32 v64, v66
    v_permlane32_swap_b32 v65, v67
    buffer_store_dwordx4 v[64:67], v12, s[12:15], s32 offen offset:192
    v_cvt_pk_bf16_f32 v68, v192, v193
    v_cvt_pk_bf16_f32 v69, v194, v195
    v_cvt_pk_bf16_f32 v70, v196, v197
    v_cvt_pk_bf16_f32 v71, v198, v199
    s_nop 0
    v_permlane32_swap_b32 v68, v70
    v_permlane32_swap_b32 v69, v71
    buffer_store_dwordx4 v[68:71], v12, s[12:15], s32 offen offset:224
    s_branch L_k2_exit
    s_nop 0
L_k2_exit:
    s_endpgm
.section .rodata,"a"
.p2align 6
.amdhsa_kernel concat_heads__linear_attn_block__ssm_conv_s4d__prompt_kernel
  .amdhsa_next_free_vgpr 256
  .amdhsa_next_free_sgpr 102
  .amdhsa_accum_offset 256
  .amdhsa_group_segment_fixed_size 0
  .amdhsa_kernarg_size 104
  .amdhsa_user_sgpr_count 2
  .amdhsa_user_sgpr_kernarg_segment_ptr 1
  .amdhsa_system_sgpr_workgroup_id_x 1
.end_amdhsa_kernel
.p2align 6
.amdhsa_kernel stage2_kernel
  .amdhsa_next_free_vgpr 256
  .amdhsa_next_free_sgpr 102
  .amdhsa_accum_offset 256
  .amdhsa_group_segment_fixed_size 0
  .amdhsa_kernarg_size 104
  .amdhsa_user_sgpr_count 2
  .amdhsa_user_sgpr_kernarg_segment_ptr 1
  .amdhsa_system_sgpr_workgroup_id_x 1
.end_amdhsa_kernel
```
